```python
import torch

def _softmax(x, axis=-1):
    return torch.softmax(x, dim=axis)
def _gelu(x):
    return torch.nn.functional.gelu(x, approximate="tanh")
def _silu(x):
    return torch.nn.functional.silu(x)
def _sigmoid(x):
    return torch.sigmoid(x)
def _layernorm(x, axis=-1, eps=1e-5):
    m = x.mean(dim=axis, keepdim=True)
    v = x.var(dim=axis, keepdim=True, unbiased=False)
    return (x - m) / torch.sqrt(v + eps)
def _scatter_add(tgt, idx, src, axis=0):
    return tgt.clone().index_add_(axis, idx, src)
def _segment_sum(src, seg, n):
    out = torch.zeros((n,) + src.shape[1:], dtype=src.dtype)
    return out.index_add_(0, seg, src)
def _pad(x, pw):
    flat = tuple(v for pair in reversed(pw) for v in pair)
    return torch.nn.functional.pad(x, flat)

kernel_name = 'standalone__winograd__vision'

def setup_inputs():

    _w = (lambda a: (lambda t: t.to(torch.bfloat16) if t.is_floating_point() else t)(torch.as_tensor(a)))
    H = W = 384 // 2 * 2
    C = 96
    return {
        "x": _w((lambda *s: torch.randn(*s, dtype=torch.bfloat16) * 0.05)(1, H, W, C)),
        "w": _w((lambda *s: torch.randn(*s, dtype=torch.bfloat16) * 0.05)(3, 3, C, C)),
    }

def reference(x, w):
    N, H, W, C = x.shape
    K = w.shape[-1]
    G  = torch.as_tensor([[1.0,0.0,0.0],[0.5,0.5,0.5],[0.5,-0.5,0.5],[0.0,0.0,1.0]], dtype=x.dtype)
    Bt = torch.as_tensor([[1.0,0.0,-1.0,0.0],[0.0,1.0,1.0,0.0],[0.0,-1.0,1.0,0.0],[0.0,1.0,0.0,-1.0]], dtype=x.dtype)
    At = torch.as_tensor([[1.0,1.0,1.0,0.0],[0.0,1.0,-1.0,-1.0]], dtype=x.dtype)
    U = torch.einsum("ar,rsck,bs->abck", G, w, G)
    xp = _pad(x, ((0,0),(1,1),(1,1),(0,0)))
    nH, nW = H // 2, W // 2
    patches = []
    for i in range(4):
        for j in range(4):
            patches.append(xp[:, i:i + 2 * nH:2, j:j + 2 * nW:2, :])
    d = torch.stack(patches).reshape(4, 4, N * nH * nW, C)
    V = torch.einsum("ai,ijpc,bj->abpc", Bt, d, Bt)
    M = torch.einsum("abck,abpc->abpk", U, V)
    Y = torch.einsum("ma,abpk,nb->pmnk", At, M, At)
    Y = Y.reshape(N, nH, nW, 2, 2, K)
    Y = (lambda x, *d: x.permute(*d))(Y, 0, 1, 3, 2, 4, 5).reshape(N, H, W, K)
    return Y
```

```asm
; @launch grid=(256,1,1) block=(256,1,1) lds=163840
.amdgcn_target "amdgcn-amd-amdhsa--gfx950"
.text
.p2align 12
.globl standalone__winograd__vision_kernel
.p2align 8
.type standalone__winograd__vision_kernel,@function
standalone__winograd__vision_kernel:
    s_cmp_ge_u32 s2, 256
    s_cbranch_scc1 L_end
    s_load_dwordx4 s[4:7], s[0:1], 0
    s_load_dwordx2 s[8:9], s[0:1], 16
    v_lshrrev_b32 v250, 6, v0
    v_and_b32 v0, 63, v0
    v_readfirstlane_b32 s96, v250
    s_and_b32 s42, s2, 7
    s_lshr_b32 s43, s2, 3
    s_cmp_lg_u32 s96, 3
    s_cbranch_scc1 L_nocpf
    s_getpc_b64 s[40:41]
L_pc:
    s_and_b32 s3, s43, 3
    s_lshl_b32 s3, s3, 13
    v_lshl_add_u32 v251, v0, 7, s3
    v_min_u32 v251, L_end-L_pc, v251
    global_load_dword v254, v251, s[40:41]
L_nocpf:
    s_mul_i32 s42, s42, 9216
    s_lshr_b32 s32, s96, 1
    s_and_b32 s33, s96, 1
    s_and_b32 s3, s43, 1
    s_mul_i32 s38, s43, 12
    s_mul_i32 s39, s3, 11
    s_add_u32 s38, s38, s39
    s_mul_i32 s38, s38, 73728
    s_mul_i32 s39, s3, 147456
    s_sub_u32 s100, 73728, s39
    s_mul_i32 s101, s3, 110592
    s_sub_u32 s99, 55296, s101
    s_sub_u32 s34, s38, s100
    s_mul_i32 s39, s32, s100
    s_add_u32 s38, s38, s39
    s_lshl_b32 s98, s100, 1
    s_mul_i32 s36, s33, 3072
    s_add_u32 s101, s101, s36
    v_lshlrev_b32 v89, 4, v0
    v_xor_b32 v91, 32, v89
    v_and_b32 v251, 32, v0
    v_xor_b32 v90, v251, v89
    s_mul_i32 s39, s96, 150
    v_add_u32 v250, s39, v0
    s_sub_u32 s37, s42, 192
    s_cmp_eq_u32 s42, 0
    s_cselect_b32 s3, 12, 0
    s_cmp_eq_u32 s42, 64512
    s_cselect_b32 s41, 12, s3
    s_sub_u32 s41, 600, s41
    v_bfrev_b32 v253, 1
    v_subrev_u32 v248, 20, v0
    v_cmp_gt_u32 vcc, 44, v0
    s_add_u32 s39, s39, 128
    s_nop 0
    v_cndmask_b32 v248, v248, v0, vcc
    v_and_b32 v249, 1, v248
    v_lshlrev_b32 v249, 3, v249
    v_lshrrev_b32 v248, 1, v248
    v_add_u32 v248, s39, v248
    v_subrev_u32 v252, s3, v250
    v_cmp_gt_u32 vcc, s41, v252
    v_lshl_add_u32 v251, v250, 4, s37
    s_nop 0
    v_cndmask_b32 v1, v253, v251, vcc
    v_mul_u32_u24 v251, 455, v250
    v_add_u32 v251, 455, v251
    v_lshrrev_b32 v251, 15, v251
    v_and_b32 v251, 2, v251
    v_xor_b32 v251, v251, v250
    v_lshlrev_b32 v4, 4, v251
    v_add_u32 v250, 64, v250
    v_subrev_u32 v252, s3, v250
    v_cmp_gt_u32 vcc, s41, v252
    v_lshl_add_u32 v251, v250, 4, s37
    s_nop 0
    v_cndmask_b32 v2, v253, v251, vcc
    v_mul_u32_u24 v251, 455, v250
    v_add_u32 v251, 455, v251
    v_lshrrev_b32 v251, 15, v251
    v_and_b32 v251, 2, v251
    v_xor_b32 v251, v251, v250
    v_lshlrev_b32 v5, 4, v251
    v_subrev_u32 v252, s3, v248
    v_cmp_gt_u32 vcc, s41, v252
    v_lshl_add_u32 v251, v248, 4, s37
    v_add_u32 v251, v251, v249
    v_cndmask_b32 v3, v253, v251, vcc
    v_mul_u32_u24 v251, 455, v248
    v_add_u32 v251, 455, v251
    v_lshrrev_b32 v251, 15, v251
    v_and_b32 v251, 2, v251
    v_xor_b32 v251, v251, v248
    v_lshl_add_u32 v6, v251, 4, v249
    s_mov_b32 s15, 0x20000
    s_mov_b32 s22, 165888
    s_mov_b32 s23, 0x20000
    s_mul_i32 s39, s32, s99
    s_add_u32 s40, s101, s39
    s_lshl_b32 s3, s99, 1
    s_add_u32 s101, s101, s3
    s_sub_u32 s3, 18432, s3
    s_mul_i32 s3, s3, s32
    s_add_u32 s41, s101, s3
    s_mul_i32 s97, s32, 49152
    s_mul_i32 s35, s32, 6144
    s_add_u32 s35, s35, s36
    s_cmp_ge_u32 s34, 28311552
    s_cselect_b32 s14, 0, 28311552
    s_cselect_b32 s39, 0, s34
    s_mul_i32 s3, s43, 3121
    s_lshr_b32 s3, s3, 16
    s_mul_i32 s3, s3, 21
    s_sub_u32 s3, s43, s3
    s_lshl_b32 s3, s3, 13
    s_cmp_eq_u32 s96, 0
    s_cselect_b32 s3, s3, 0x40000000
    v_lshl_add_u32 v247, v0, 7, s3
    s_waitcnt lgkmcnt(0)
    s_mov_b32 s12, s4
    s_mov_b32 s13, s5
    s_mov_b32 s20, s6
    s_mov_b32 s21, s7
    s_mov_b32 s4, s40
    s_add_u32 s5, s40, s99
    s_mov_b32 s6, s41
    s_sub_u32 s7, s41, s97
    s_mov_b32 s97, s39
    s_cmp_lg_u32 s96, 0
    s_cbranch_scc1 L_nowpf
    buffer_load_dword v255, v247, s[20:23], 0 offen
L_nowpf:
    s_add_u32 m0, s35, 129024
    s_add_u32 s37, s4, 0
    buffer_load_dwordx4 v89, s[20:23], s37 offen offset:0 lds
    s_mov_b32 s24, s8
    s_mov_b32 s25, s9
    s_mov_b32 s26, 28311552
    s_mov_b32 s27, 0x20000
    s_mov_b32 s16, 0xffff0000
    s_lshl_b32 s17, s32, 31
    s_xor_b32 s17, s17, 0xbf800000
    v_add_u32 v7, 38400, v4
    v_add_u32 v8, 38400, v5
    buffer_load_dwordx4 v90, s[20:23], s37 offen offset:1024 lds
    v_add_u32 v9, 38400, v6
    v_and_b32 v250, 15, v0
    v_lshrrev_b32 v251, 4, v0
    v_lshrrev_b32 v252, 2, v250
    v_lshl_add_u32 v252, v251, 3, v252
    v_mul_u32_u24 v252, 192, v252
    v_and_b32 v253, 3, v250
    v_lshl_add_u32 v252, v253, 3, v252
    v_and_b32 v253, 1, v251
    buffer_load_dwordx4 v91, s[20:23], s37 offen offset:2048 lds
    v_lshlrev_b32 v253, 5, v253
    s_mul_i32 s40, s33, 96
    s_mul_i32 s41, s32, 12288
    s_add_u32 s18, s41, 73728
    s_sub_u32 s19, 86016, s41
    s_add_u32 s3, s40, 0
    v_xor_b32 v248, s3, v253
    v_add_u32 v248, v248, v252
    v_add_u32 v80, s18, v248
    s_mul_i32 s39, s32, -147456
    s_add_u32 s39, s39, s35
    s_add_u32 m0, s39, 141312
    s_add_u32 s37, s6, 0
    buffer_load_dwordx4 v89, s[20:23], s37 offen offset:0 lds
    s_add_u32 s3, s40, 32
    v_xor_b32 v248, s3, v253
    v_add_u32 v248, v248, v252
    v_add_u32 v81, s18, v248
    s_add_u32 s3, s40, 64
    v_xor_b32 v248, s3, v253
    v_add_u32 v248, v248, v252
    v_add_u32 v82, s18, v248
    v_lshrrev_b32 v252, 2, v250
    buffer_load_dwordx4 v90, s[20:23], s37 offen offset:1024 lds
    v_and_b32 v248, 3, v250
    v_lshl_add_u32 v248, v252, 3, v248
    v_mul_u32_u24 v248, 192, v248
    v_mov_b32 v249, 79872
    v_mov_b32 v253, s19
    v_cmp_gt_u32 vcc, 2, v251
    v_and_b32 v252, 1, v252
    v_lshlrev_b32 v252, 5, v252
    v_cndmask_b32 v249, v253, v249, vcc
    v_add_u32 v248, v248, v249
    buffer_load_dwordx4 v91, s[20:23], s37 offen offset:2048 lds
    v_and_b32 v249, 1, v251
    v_lshl_add_u32 v248, v249, 4, v248
    s_add_u32 s3, s40, 0
    v_xor_b32 v249, s3, v252
    v_add_u32 v83, v249, v248
    s_add_u32 s3, s40, 32
    v_xor_b32 v249, s3, v252
    v_add_u32 v84, v249, v248
    s_add_u32 s3, s40, 64
    v_xor_b32 v249, s3, v252
    s_add_u32 m0, s35, 6144
    s_add_u32 s37, s5, 18432
    buffer_load_dwordx4 v89, s[20:23], s37 offen offset:0 lds
    v_add_u32 v85, v249, v248
    v_lshrrev_b32 v252, 2, v250
    v_cmp_eq_u32 vcc, v252, v251
    v_and_b32 v253, 1, v250
    v_lshlrev_b32 v253, 4, v253
    v_mov_b32 v248, 0x3f00
    v_lshlrev_b32 v248, v253, v248
    v_cndmask_b32 v248, 0, v248, vcc
    v_and_b32 v252, 2, v250
    v_cmp_eq_u32 vcc, 0, v252
    buffer_load_dwordx4 v90, s[20:23], s37 offen offset:1024 lds
    s_lshl_b32 s3, s32, 15
    v_lshlrev_b32 v249, v253, s3
    v_cndmask_b32 v98, 0, v248, vcc
    v_cndmask_b32 v99, v248, 0, vcc
    v_xor_b32 v102, v249, v98
    v_xor_b32 v103, v249, v99
    v_mov_b32 v96, 0
    v_mov_b32 v97, 0
    v_mov_b32 v100, 0
    v_mov_b32 v101, 0
    buffer_load_dwordx4 v91, s[20:23], s37 offen offset:2048 lds
    v_lshrrev_b32 v252, 3, v250
    v_and_b32 v248, 1, v251
    v_cmp_eq_u32 vcc, v252, v248
    v_mov_b32 v248, 0x3f00
    v_or_b32 v249, s3, v248
    v_cmp_gt_u32 s[0:1], 2, v251
    v_bfe_u32 v252, v250, 1, 2
    s_nop 0
    v_cndmask_b32 v248, v248, v249, s[0:1]
    v_lshlrev_b32 v248, v253, v248
    s_add_u32 m0, s35, 18432
    s_add_u32 s37, s4, 36864
    buffer_load_dwordx4 v89, s[20:23], s37 offen offset:0 lds
    v_cndmask_b32 v248, 0, v248, vcc
    v_cmp_eq_u32 vcc, 0, v252
    s_nop 1
    v_cndmask_b32 v102, 0, v248, vcc
    v_cmp_eq_u32 vcc, 1, v252
    s_nop 1
    v_cndmask_b32 v103, 0, v248, vcc
    v_cmp_eq_u32 vcc, 2, v252
    s_nop 1
    v_cndmask_b32 v104, 0, v248, vcc
    buffer_load_dwordx4 v90, s[20:23], s37 offen offset:1024 lds
    v_cmp_eq_u32 vcc, 3, v252
    s_nop 1
    v_cndmask_b32 v105, 0, v248, vcc
    v_mul_u32_u24 v252, 576, v250
    s_add_u32 s3, s32, 1
    s_mul_i32 s18, s3, 9600
    s_mul_i32 s19, s32, 28800
    v_lshrrev_b32 v253, 1, v250
    v_and_b32 v253, 2, v253
    v_xor_b32 v253, v253, v251
    buffer_load_dwordx4 v91, s[20:23], s37 offen offset:2048 lds
    v_lshl_add_u32 v248, v253, 4, v252
    v_add_u32 v10, s18, v248
    v_add_u32 v12, s19, v248
    v_add_u32 v253, 1, v250
    v_lshrrev_b32 v253, 1, v253
    v_and_b32 v253, 2, v253
    v_xor_b32 v253, v253, v251
    v_lshl_add_u32 v248, v253, 4, v252
    v_add_u32 v11, s18, v248
    v_add_u32 v13, s19, v248
    s_mov_b64 exec, 0
    s_cmp_eq_u32 s96, 0
    s_cbranch_scc1 L_stub0
    s_cmp_eq_u32 s96, 1
    s_cbranch_scc1 L_stub1
    s_cmp_eq_u32 s96, 2
    s_cbranch_scc1 L_stub2
    s_branch L_stub3
L_back:
    s_mov_b64 exec, -1
    s_add_u32 m0, s35, 30720
    s_add_u32 s37, s7, 36864
    buffer_load_dwordx4 v89, s[20:23], s37 offen offset:0 lds
    buffer_load_dwordx4 v90, s[20:23], s37 offen offset:1024 lds
    buffer_load_dwordx4 v91, s[20:23], s37 offen offset:2048 lds
    s_add_u32 m0, s35, 43008
    s_add_u32 s37, s5, 6144
    buffer_load_dwordx4 v89, s[20:23], s37 offen offset:0 lds
    buffer_load_dwordx4 v90, s[20:23], s37 offen offset:1024 lds
    buffer_load_dwordx4 v91, s[20:23], s37 offen offset:2048 lds
    s_add_u32 m0, s35, 55296
    s_add_u32 s37, s4, 24576
    buffer_load_dwordx4 v89, s[20:23], s37 offen offset:0 lds
    buffer_load_dwordx4 v90, s[20:23], s37 offen offset:1024 lds
    buffer_load_dwordx4 v91, s[20:23], s37 offen offset:2048 lds
    s_waitcnt vmcnt(15)
    s_barrier
    ds_read_b64_tr_b16 a[0:1], v80 offset:55296
    ds_read_b64_tr_b16 a[2:3], v80 offset:56064
    ds_read_b128 v[24:27], v83 offset:55296
    ds_read_b128 v[28:31], v83 offset:56064
    ds_read_b64_tr_b16 a[4:5], v81 offset:55296
    ds_read_b64_tr_b16 a[6:7], v81 offset:56064
    ds_read_b128 v[32:35], v84 offset:55296
    ds_read_b128 v[36:39], v84 offset:56064
    s_waitcnt lgkmcnt(4)
    v_mfma_f32_16x16x32_bf16 v[48:51], v[98:101], a[0:3], 0
    s_add_u32 m0, s35, 67584
    s_add_u32 s37, s6, 24576
    ds_read_b64_tr_b16 a[8:9], v82 offset:55296
    v_mfma_f32_16x16x32_bf16 v[52:55], v[96:99], a[0:3], 0
    buffer_load_dwordx4 v89, s[20:23], s37 offen offset:0 lds
    ds_read_b64_tr_b16 a[10:11], v82 offset:56064
    v_mfma_f32_16x16x32_bf16 v[48:51], v[24:27], v[102:105], v[48:51]
    ds_read_b128 v[40:43], v85 offset:55296
    v_and_b32 v152, 15, v0
    v_mfma_f32_16x16x32_bf16 v[52:55], v[28:31], v[102:105], v[52:55]
    buffer_load_dwordx4 v90, s[20:23], s37 offen offset:1024 lds
    s_waitcnt lgkmcnt(3)
    s_waitcnt vmcnt(14)
    s_barrier
    ds_read_b128 v[44:47], v85 offset:56064
    v_add_u32 v80, 4294893568, v80
    v_add_u32 v81, 4294893568, v81
    v_add_u32 v82, 4294893568, v82
    v_add_u32 v83, 4294893568, v83
    v_add_u32 v84, 4294893568, v84
    v_add_u32 v85, 4294893568, v85
    v_mfma_f32_16x16x32_bf16 v[56:59], v[98:101], a[4:7], 0
    ds_read_b64_tr_b16 a[12:13], v80 offset:0
    v_lshrrev_b32 v153, 4, v0
    v_mfma_f32_16x16x32_bf16 v[92:95], v[96:99], a[4:7], 0
    buffer_load_dwordx4 v91, s[20:23], s37 offen offset:2048 lds
    ds_read_b64_tr_b16 a[14:15], v80 offset:768
    v_cvt_pk_bf16_f32 v200, v48, v49
    v_mfma_f32_16x16x32_bf16 v[56:59], v[32:35], v[102:105], v[56:59]
    s_add_u32 m0, s35, 79872
    s_add_u32 s37, s5, 43008
    s_mul_i32 s0, s96, 9216
    ds_read_b128 v[24:27], v83 offset:0
    v_cvt_pk_bf16_f32 v201, v50, v51
    v_cvt_pk_bf16_f32 v202, v52, v53
    v_mfma_f32_16x16x32_bf16 v[92:95], v[36:39], v[102:105], v[92:95]
    buffer_load_dwordx4 v89, s[20:23], s37 offen offset:0 lds
    s_waitcnt lgkmcnt(3)
    s_add_u32 s0, s0, 76800
    ds_read_b128 v[28:31], v83 offset:768
    v_cvt_pk_bf16_f32 v203, v54, v55
    v_mfma_f32_16x16x32_bf16 v[48:51], v[98:101], a[8:11], 0
    ds_read_b64_tr_b16 a[16:17], v81 offset:0
    v_lshl_add_u32 v14, v0, 4, s0
    v_mfma_f32_16x16x32_bf16 v[52:55], v[96:99], a[8:11], 0
    buffer_load_dwordx4 v90, s[20:23], s37 offen offset:1024 lds
    s_xor_b32 s0, s96, 2
    ds_read_b64_tr_b16 a[18:19], v81 offset:768
    v_cvt_pk_bf16_f32 v248, v56, v57
    v_mfma_f32_16x16x32_bf16 v[48:51], v[40:43], v[102:105], v[48:51]
    ds_read_b128 v[32:35], v84 offset:0
    v_cvt_pk_bf16_f32 v249, v58, v59
    v_cvt_pk_bf16_f32 v250, v92, v93
    v_mfma_f32_16x16x32_bf16 v[52:55], v[44:47], v[102:105], v[52:55]
    buffer_load_dwordx4 v91, s[20:23], s37 offen offset:2048 lds
    s_waitcnt lgkmcnt(3)
    s_mul_i32 s0, s0, 9216
    ds_read_b128 v[36:39], v84 offset:768
    v_cvt_pk_bf16_f32 v251, v94, v95
    v_mfma_f32_16x16x32_bf16 v[56:59], v[98:101], a[12:15], 0
    s_add_u32 m0, s35, 92160
    s_add_u32 s37, s4, 12288
    s_add_u32 s0, s0, 76800
    ds_read_b64_tr_b16 a[20:21], v82 offset:0
    v_accvgpr_write_b32 a108, v248
    v_accvgpr_write_b32 a109, v249
    v_mfma_f32_16x16x32_bf16 v[92:95], v[96:99], a[12:15], 0
    buffer_load_dwordx4 v89, s[20:23], s37 offen offset:0 lds
    ds_read_b64_tr_b16 a[22:23], v82 offset:768
    v_lshl_add_u32 v15, v0, 4, s0
    v_accvgpr_write_b32 a110, v250
    v_accvgpr_write_b32 a111, v251
    v_cvt_pk_bf16_f32 v204, v48, v49
    v_mfma_f32_16x16x32_bf16 v[56:59], v[24:27], v[102:105], v[56:59]
    s_mul_i32 s1, s32, 9472
    ds_read_b128 v[40:43], v85 offset:0
    v_cvt_pk_bf16_f32 v205, v50, v51
    v_cvt_pk_bf16_f32 v206, v52, v53
    v_mfma_f32_16x16x32_bf16 v[92:95], v[28:31], v[102:105], v[92:95]
    buffer_load_dwordx4 v90, s[20:23], s37 offen offset:1024 lds
    s_waitcnt lgkmcnt(3)
    s_waitcnt vmcnt(14)
    s_barrier
    s_mul_i32 s0, s33, 96
    ds_read_b128 v[44:47], v85 offset:768
    v_cvt_pk_bf16_f32 v207, v54, v55
    v_mfma_f32_16x16x32_bf16 v[48:51], v[98:101], a[16:19], 0
    s_add_u32 s1, s1, 113664
    ds_read_b64_tr_b16 a[24:25], v80 offset:18432
    v_mfma_f32_16x16x32_bf16 v[52:55], v[96:99], a[16:19], 0
    buffer_load_dwordx4 v91, s[20:23], s37 offen offset:2048 lds
    ds_read_b64_tr_b16 a[26:27], v80 offset:19200
    v_cvt_pk_bf16_f32 v248, v56, v57
    v_mfma_f32_16x16x32_bf16 v[48:51], v[32:35], v[102:105], v[48:51]
    s_add_u32 m0, s35, 104448
    s_add_u32 s37, s6, 12288
    s_add_u32 s0, s0, s1
    ds_read_b128 v[24:27], v83 offset:18432
    v_cvt_pk_bf16_f32 v249, v58, v59
    v_cvt_pk_bf16_f32 v250, v92, v93
    v_mfma_f32_16x16x32_bf16 v[52:55], v[36:39], v[102:105], v[52:55]
    buffer_load_dwordx4 v89, s[20:23], s37 offen offset:0 lds
    s_waitcnt lgkmcnt(3)
    ds_read_b128 v[28:31], v83 offset:19200
    v_mul_u32_u24 v154, 592, v152
    v_cvt_pk_bf16_f32 v251, v94, v95
    v_mfma_f32_16x16x32_bf16 v[56:59], v[98:101], a[20:23], 0
    ds_read_b64_tr_b16 a[28:29], v81 offset:18432
    v_lshl_add_u32 v154, v153, 3, v154
    v_accvgpr_write_b32 a112, v248
    v_accvgpr_write_b32 a113, v249
    v_mfma_f32_16x16x32_bf16 v[92:95], v[96:99], a[20:23], 0
    buffer_load_dwordx4 v90, s[20:23], s37 offen offset:1024 lds
    ds_read_b64_tr_b16 a[30:31], v81 offset:19200
    v_add_u32 v16, s0, v154
    v_accvgpr_write_b32 a114, v250
    v_accvgpr_write_b32 a115, v251
    v_cvt_pk_bf16_f32 v208, v48, v49
    v_mfma_f32_16x16x32_bf16 v[56:59], v[40:43], v[102:105], v[56:59]
    s_mul_i32 s0, s33, 288
    ds_read_b128 v[32:35], v84 offset:18432
    v_cvt_pk_bf16_f32 v209, v50, v51
    v_cvt_pk_bf16_f32 v210, v52, v53
    v_mfma_f32_16x16x32_bf16 v[92:95], v[44:47], v[102:105], v[92:95]
    buffer_load_dwordx4 v91, s[20:23], s37 offen offset:2048 lds
    s_waitcnt lgkmcnt(3)
    ds_read_b128 v[36:39], v84 offset:19200
    v_add_u32 v152, s0, v0
    v_cvt_pk_bf16_f32 v211, v54, v55
    v_mfma_f32_16x16x32_bf16 v[48:51], v[98:101], a[24:27], 0
    s_add_u32 m0, s35, 116736
    s_add_u32 s37, s5, 30720
    ds_read_b64_tr_b16 a[32:33], v82 offset:18432
    v_mfma_f32_16x16x32_bf16 v[52:55], v[96:99], a[24:27], 0
    buffer_load_dwordx4 v89, s[20:23], s37 offen offset:0 lds
    ds_read_b64_tr_b16 a[34:35], v82 offset:19200
    v_lshl_add_u32 v22, v152, 4, s42
    v_cvt_pk_bf16_f32 v248, v56, v57
    v_mfma_f32_16x16x32_bf16 v[48:51], v[24:27], v[102:105], v[48:51]
    ds_read_b128 v[40:43], v85 offset:18432
    v_add_u32 v154, 4096, v22
    v_cvt_pk_bf16_f32 v249, v58, v59
    v_cvt_pk_bf16_f32 v250, v92, v93
    v_mfma_f32_16x16x32_bf16 v[52:55], v[28:31], v[102:105], v[52:55]
    buffer_load_dwordx4 v90, s[20:23], s37 offen offset:1024 lds
    s_waitcnt lgkmcnt(3)
    s_waitcnt vmcnt(11)
    s_barrier
    ds_read_b128 v[44:47], v85 offset:19200
    v_bfrev_b32 v155, 1
    v_cvt_pk_bf16_f32 v251, v94, v95
    v_mfma_f32_16x16x32_bf16 v[56:59], v[98:101], a[28:31], 0
    ds_read_b64_tr_b16 a[36:37], v80 offset:36864
    v_cmp_gt_u32 vcc, 32, v0
    v_accvgpr_write_b32 a116, v248
    v_accvgpr_write_b32 a117, v249
    v_mfma_f32_16x16x32_bf16 v[92:95], v[96:99], a[28:31], 0
    buffer_load_dwordx4 v91, s[20:23], s37 offen offset:2048 lds
    s_nop 1
    ds_read_b64_tr_b16 a[38:39], v80 offset:37632
    v_accvgpr_write_b32 a118, v250
    v_accvgpr_write_b32 a119, v251
    v_cvt_pk_bf16_f32 v212, v48, v49
    v_mfma_f32_16x16x32_bf16 v[56:59], v[32:35], v[102:105], v[56:59]
    s_add_u32 m0, s35, 129024
    s_add_u32 s37, s4, 49152
    ds_read_b128 v[24:27], v83 offset:36864
    v_cndmask_b32 v23, v155, v154, vcc
    v_cvt_pk_bf16_f32 v213, v50, v51
    v_cvt_pk_bf16_f32 v214, v52, v53
    v_mfma_f32_16x16x32_bf16 v[92:95], v[36:39], v[102:105], v[92:95]
    buffer_load_dwordx4 v89, s[20:23], s37 offen offset:0 lds
    s_waitcnt lgkmcnt(3)
    ds_read_b128 v[28:31], v83 offset:37632
    v_mul_u32_u24 v153, 1821, v152
    v_cvt_pk_bf16_f32 v215, v54, v55
    v_mfma_f32_16x16x32_bf16 v[48:51], v[98:101], a[32:35], 0
    ds_read_b64_tr_b16 a[40:41], v81 offset:36864
    v_lshrrev_b32 v153, 16, v153
    v_mfma_f32_16x16x32_bf16 v[52:55], v[96:99], a[32:35], 0
    buffer_load_dwordx4 v90, s[20:23], s37 offen offset:1024 lds
    ds_read_b64_tr_b16 a[42:43], v81 offset:37632
    v_cvt_pk_bf16_f32 v248, v56, v57
    v_mfma_f32_16x16x32_bf16 v[48:51], v[40:43], v[102:105], v[48:51]
    ds_read_b128 v[32:35], v84 offset:36864
    v_add_u32 v153, v153, v152
    v_cvt_pk_bf16_f32 v249, v58, v59
    v_cvt_pk_bf16_f32 v250, v92, v93
    v_mfma_f32_16x16x32_bf16 v[52:55], v[44:47], v[102:105], v[52:55]
    buffer_load_dwordx4 v91, s[20:23], s37 offen offset:2048 lds
    s_waitcnt lgkmcnt(3)
    ds_read_b128 v[36:39], v84 offset:37632
    v_lshl_add_u32 v17, v153, 4, s1
    v_cvt_pk_bf16_f32 v251, v94, v95
    v_mfma_f32_16x16x32_bf16 v[56:59], v[98:101], a[36:39], 0
    s_add_u32 m0, s35, 141312
    s_add_u32 s37, s101, 49152
    ds_read_b64_tr_b16 a[44:45], v82 offset:36864
    v_add_u32 v152, 64, v152
    v_accvgpr_write_b32 a120, v248
    v_accvgpr_write_b32 a121, v249
    v_mfma_f32_16x16x32_bf16 v[92:95], v[96:99], a[36:39], 0
    buffer_load_dwordx4 v89, s[20:23], s37 offen offset:0 lds
    ds_read_b64_tr_b16 a[46:47], v82 offset:37632
    v_mul_u32_u24 v153, 1821, v152
    v_accvgpr_write_b32 a122, v250
    v_accvgpr_write_b32 a123, v251
    v_cvt_pk_bf16_f32 v216, v48, v49
    v_mfma_f32_16x16x32_bf16 v[56:59], v[24:27], v[102:105], v[56:59]
    ds_read_b128 v[40:43], v85 offset:36864
    v_lshrrev_b32 v153, 16, v153
    v_cvt_pk_bf16_f32 v217, v50, v51
    v_cvt_pk_bf16_f32 v218, v52, v53
    v_mfma_f32_16x16x32_bf16 v[92:95], v[28:31], v[102:105], v[92:95]
    buffer_load_dwordx4 v90, s[20:23], s37 offen offset:1024 lds
    s_waitcnt lgkmcnt(3)
    ds_read_b128 v[44:47], v85 offset:37632
    v_cvt_pk_bf16_f32 v219, v54, v55
    v_mfma_f32_16x16x32_bf16 v[48:51], v[98:101], a[40:43], 0
    ds_read_b64_tr_b16 a[48:49], v80 offset:55296
    v_add_u32 v153, v153, v152
    v_mfma_f32_16x16x32_bf16 v[52:55], v[96:99], a[40:43], 0
    buffer_load_dwordx4 v91, s[20:23], s37 offen offset:2048 lds
    ds_read_b64_tr_b16 a[50:51], v80 offset:56064
    v_lshl_add_u32 v18, v153, 4, s1
    v_cvt_pk_bf16_f32 v248, v56, v57
    v_mfma_f32_16x16x32_bf16 v[48:51], v[32:35], v[102:105], v[48:51]
L_stub0:
    s_cbranch_execz L_stub4
    ds_read_b128 v[24:27], v83 offset:55296
    v_add_u32 v152, 64, v152
    v_cvt_pk_bf16_f32 v249, v58, v59
    v_cvt_pk_bf16_f32 v250, v92, v93
    v_mfma_f32_16x16x32_bf16 v[52:55], v[36:39], v[102:105], v[52:55]
    buffer_load_dwordx4 v[60:63], v1, s[12:15], s97 offen
    s_waitcnt lgkmcnt(3)
    ds_read_b128 v[28:31], v83 offset:56064
    v_mul_u32_u24 v153, 1821, v152
    v_cvt_pk_bf16_f32 v251, v94, v95
    v_mfma_f32_16x16x32_bf16 v[56:59], v[98:101], a[44:47], 0
    ds_read_b64_tr_b16 a[52:53], v81 offset:55296
    v_lshrrev_b32 v153, 16, v153
    v_accvgpr_write_b32 a124, v248
    v_accvgpr_write_b32 a125, v249
    v_mfma_f32_16x16x32_bf16 v[92:95], v[96:99], a[44:47], 0
    buffer_load_dwordx4 v[64:67], v2, s[12:15], s97 offen
    ds_read_b64_tr_b16 a[54:55], v81 offset:56064
    v_add_u32 v153, v153, v152
    v_accvgpr_write_b32 a126, v250
    v_accvgpr_write_b32 a127, v251
    v_cvt_pk_bf16_f32 v220, v48, v49
    v_mfma_f32_16x16x32_bf16 v[56:59], v[40:43], v[102:105], v[56:59]
    ds_read_b128 v[32:35], v84 offset:55296
    v_cvt_pk_bf16_f32 v221, v50, v51
    v_cvt_pk_bf16_f32 v222, v52, v53
    v_mfma_f32_16x16x32_bf16 v[92:95], v[44:47], v[102:105], v[92:95]
    buffer_load_dwordx2 v[68:69], v3, s[12:15], s97 offen
    s_waitcnt lgkmcnt(3)
    ds_read_b128 v[36:39], v84 offset:56064
    v_lshl_add_u32 v19, v153, 4, s1
    v_cvt_pk_bf16_f32 v223, v54, v55
    v_mfma_f32_16x16x32_bf16 v[48:51], v[98:101], a[48:51], 0
    s_add_u32 s34, s34, s100
    s_mov_b32 s14, 28311552
    ds_read_b64_tr_b16 a[56:57], v82 offset:55296
    v_add_u32 v152, 64, v152
    v_mfma_f32_16x16x32_bf16 v[52:55], v[96:99], a[48:51], 0
    buffer_load_dwordx4 v[72:75], v1, s[12:15], s34 offen
    ds_read_b64_tr_b16 a[58:59], v82 offset:56064
    v_mul_u32_u24 v153, 1821, v152
    v_cvt_pk_bf16_f32 v248, v56, v57
    v_mfma_f32_16x16x32_bf16 v[48:51], v[24:27], v[102:105], v[48:51]
    ds_read_b128 v[40:43], v85 offset:55296
    v_lshrrev_b32 v153, 16, v153
    v_cvt_pk_bf16_f32 v249, v58, v59
    v_cvt_pk_bf16_f32 v250, v92, v93
    v_mfma_f32_16x16x32_bf16 v[52:55], v[28:31], v[102:105], v[52:55]
    buffer_load_dwordx4 v[76:79], v2, s[12:15], s34 offen
    s_waitcnt lgkmcnt(3)
    s_waitcnt vmcnt(14)
    s_barrier
    ds_read_b128 v[44:47], v85 offset:56064
    v_add_u32 v153, v153, v152
    v_add_u32 v80, 73728, v80
    v_add_u32 v81, 73728, v81
    v_add_u32 v82, 73728, v82
    v_add_u32 v83, 73728, v83
    v_add_u32 v84, 73728, v84
    v_add_u32 v85, 73728, v85
    v_cvt_pk_bf16_f32 v251, v94, v95
    v_mfma_f32_16x16x32_bf16 v[56:59], v[98:101], a[52:55], 0
    ds_read_b64_tr_b16 a[60:61], v80 offset:0
    v_lshl_add_u32 v20, v153, 4, s1
    v_accvgpr_write_b32 a128, v248
    v_accvgpr_write_b32 a129, v249
    v_mfma_f32_16x16x32_bf16 v[92:95], v[96:99], a[52:55], 0
    buffer_load_dwordx2 v[70:71], v3, s[12:15], s34 offen
    ds_read_b64_tr_b16 a[62:63], v80 offset:768
    v_accvgpr_write_b32 a130, v250
    v_accvgpr_write_b32 a131, v251
    v_cvt_pk_bf16_f32 v224, v48, v49
    v_mfma_f32_16x16x32_bf16 v[56:59], v[32:35], v[102:105], v[56:59]
    s_add_u32 s34, s34, s100
    ds_read_b128 v[24:27], v83 offset:0
    v_add_u32 v152, 64, v152
    v_cvt_pk_bf16_f32 v225, v50, v51
    v_cvt_pk_bf16_f32 v226, v52, v53
    v_mfma_f32_16x16x32_bf16 v[92:95], v[36:39], v[102:105], v[92:95]
    buffer_load_dwordx4 v[132:135], v1, s[12:15], s34 offen
    s_waitcnt lgkmcnt(3)
    ds_read_b128 v[28:31], v83 offset:768
    v_min_u32 v152, 575, v152
    v_cvt_pk_bf16_f32 v227, v54, v55
    v_mfma_f32_16x16x32_bf16 v[48:51], v[98:101], a[56:59], 0
    ds_read_b64_tr_b16 a[64:65], v81 offset:0
    v_mul_u32_u24 v153, 1821, v152
    v_mfma_f32_16x16x32_bf16 v[52:55], v[96:99], a[56:59], 0
    buffer_load_dwordx4 v[136:139], v2, s[12:15], s34 offen
    ds_read_b64_tr_b16 a[66:67], v81 offset:768
    v_lshrrev_b32 v153, 16, v153
    v_cvt_pk_bf16_f32 v248, v56, v57
    v_mfma_f32_16x16x32_bf16 v[48:51], v[40:43], v[102:105], v[48:51]
    ds_read_b128 v[32:35], v84 offset:0
    v_add_u32 v153, v153, v152
    v_cvt_pk_bf16_f32 v249, v58, v59
    v_cvt_pk_bf16_f32 v250, v92, v93
    v_mfma_f32_16x16x32_bf16 v[52:55], v[44:47], v[102:105], v[52:55]
    buffer_load_dwordx2 v[140:141], v3, s[12:15], s34 offen
    s_waitcnt lgkmcnt(3)
    ds_read_b128 v[36:39], v84 offset:768
    v_lshl_add_u32 v21, v153, 4, s1
    v_cvt_pk_bf16_f32 v251, v94, v95
    v_mfma_f32_16x16x32_bf16 v[56:59], v[98:101], a[60:63], 0
    s_add_u32 s34, s34, s100
    ds_read_b64_tr_b16 a[68:69], v82 offset:0
    v_add_u32 v152, 64, v152
    v_accvgpr_write_b32 a132, v248
    v_accvgpr_write_b32 a133, v249
    v_mfma_f32_16x16x32_bf16 v[92:95], v[96:99], a[60:63], 0
    buffer_load_dwordx4 v[144:147], v1, s[12:15], s34 offen
    ds_read_b64_tr_b16 a[70:71], v82 offset:768
    v_accvgpr_write_b32 a134, v250
    v_accvgpr_write_b32 a135, v251
    v_cvt_pk_bf16_f32 v228, v48, v49
    v_mfma_f32_16x16x32_bf16 v[56:59], v[24:27], v[102:105], v[56:59]
    ds_read_b128 v[40:43], v85 offset:0
    v_cvt_pk_bf16_f32 v229, v50, v51
    v_cvt_pk_bf16_f32 v230, v52, v53
    v_mfma_f32_16x16x32_bf16 v[92:95], v[28:31], v[102:105], v[92:95]
    buffer_load_dwordx4 v[148:151], v2, s[12:15], s34 offen
    s_waitcnt lgkmcnt(3)
    ds_read_b128 v[44:47], v85 offset:768
    v_cvt_pk_bf16_f32 v231, v54, v55
    v_mfma_f32_16x16x32_bf16 v[48:51], v[98:101], a[64:67], 0
    ds_read_b64_tr_b16 a[72:73], v80 offset:18432
    v_mfma_f32_16x16x32_bf16 v[52:55], v[96:99], a[64:67], 0
    buffer_load_dwordx2 v[142:143], v3, s[12:15], s34 offen
    ds_read_b64_tr_b16 a[74:75], v80 offset:19200
    v_cvt_pk_bf16_f32 v248, v56, v57
    v_mfma_f32_16x16x32_bf16 v[48:51], v[32:35], v[102:105], v[48:51]
    ds_read_b128 v[24:27], v83 offset:18432
    v_cvt_pk_bf16_f32 v249, v58, v59
    v_cvt_pk_bf16_f32 v250, v92, v93
    v_mfma_f32_16x16x32_bf16 v[52:55], v[36:39], v[102:105], v[52:55]
    s_waitcnt lgkmcnt(3)
    ds_read_b128 v[28:31], v83 offset:19200
    v_cvt_pk_bf16_f32 v251, v94, v95
    v_mfma_f32_16x16x32_bf16 v[56:59], v[98:101], a[68:71], 0
    ds_read_b64_tr_b16 a[76:77], v81 offset:18432
    v_accvgpr_write_b32 a136, v248
    v_accvgpr_write_b32 a137, v249
    v_mfma_f32_16x16x32_bf16 v[92:95], v[96:99], a[68:71], 0
    ds_read_b64_tr_b16 a[78:79], v81 offset:19200
    v_accvgpr_write_b32 a138, v250
    v_accvgpr_write_b32 a139, v251
    v_cvt_pk_bf16_f32 v232, v48, v49
    v_mfma_f32_16x16x32_bf16 v[56:59], v[40:43], v[102:105], v[56:59]
    ds_read_b128 v[32:35], v84 offset:18432
    v_cvt_pk_bf16_f32 v233, v50, v51
    v_cvt_pk_bf16_f32 v234, v52, v53
    v_mfma_f32_16x16x32_bf16 v[92:95], v[44:47], v[102:105], v[92:95]
    s_waitcnt lgkmcnt(3)
    ds_read_b128 v[36:39], v84 offset:19200
    v_cvt_pk_bf16_f32 v235, v54, v55
    v_mfma_f32_16x16x32_bf16 v[48:51], v[98:101], a[72:75], 0
    ds_read_b64_tr_b16 a[80:81], v82 offset:18432
    v_mfma_f32_16x16x32_bf16 v[52:55], v[96:99], a[72:75], 0
    ds_read_b64_tr_b16 a[82:83], v82 offset:19200
    v_cvt_pk_bf16_f32 v248, v56, v57
    v_mfma_f32_16x16x32_bf16 v[48:51], v[24:27], v[102:105], v[48:51]
    ds_read_b128 v[40:43], v85 offset:18432
    v_cvt_pk_bf16_f32 v249, v58, v59
    v_cvt_pk_bf16_f32 v250, v92, v93
    v_mfma_f32_16x16x32_bf16 v[52:55], v[28:31], v[102:105], v[52:55]
    s_waitcnt lgkmcnt(3)
    s_waitcnt vmcnt(12)
    s_barrier
    ds_read_b128 v[44:47], v85 offset:19200
    v_cvt_pk_bf16_f32 v251, v94, v95
    v_mfma_f32_16x16x32_bf16 v[56:59], v[98:101], a[76:79], 0
    ds_read_b64_tr_b16 a[84:85], v80 offset:36864
    v_accvgpr_write_b32 a140, v248
    v_accvgpr_write_b32 a141, v249
    v_mfma_f32_16x16x32_bf16 v[92:95], v[96:99], a[76:79], 0
    ds_read_b64_tr_b16 a[86:87], v80 offset:37632
    v_accvgpr_write_b32 a142, v250
    v_accvgpr_write_b32 a143, v251
    v_cvt_pk_bf16_f32 v236, v48, v49
    v_mfma_f32_16x16x32_bf16 v[56:59], v[32:35], v[102:105], v[56:59]
    ds_read_b128 v[24:27], v83 offset:36864
    v_cvt_pk_bf16_f32 v237, v50, v51
    v_cvt_pk_bf16_f32 v238, v52, v53
    v_mfma_f32_16x16x32_bf16 v[92:95], v[36:39], v[102:105], v[92:95]
    s_waitcnt lgkmcnt(3)
    ds_read_b128 v[28:31], v83 offset:37632
    v_cvt_pk_bf16_f32 v239, v54, v55
    v_mfma_f32_16x16x32_bf16 v[48:51], v[98:101], a[80:83], 0
    ds_read_b64_tr_b16 a[88:89], v81 offset:36864
    v_mfma_f32_16x16x32_bf16 v[52:55], v[96:99], a[80:83], 0
    ds_read_b64_tr_b16 a[90:91], v81 offset:37632
    v_cvt_pk_bf16_f32 v248, v56, v57
    v_mfma_f32_16x16x32_bf16 v[48:51], v[40:43], v[102:105], v[48:51]
    ds_read_b128 v[32:35], v84 offset:36864
    v_cvt_pk_bf16_f32 v249, v58, v59
    v_cvt_pk_bf16_f32 v250, v92, v93
    v_mfma_f32_16x16x32_bf16 v[52:55], v[44:47], v[102:105], v[52:55]
    s_waitcnt lgkmcnt(3)
    ds_read_b128 v[36:39], v84 offset:37632
    v_cvt_pk_bf16_f32 v251, v94, v95
    v_mfma_f32_16x16x32_bf16 v[56:59], v[98:101], a[84:87], 0
    ds_read_b64_tr_b16 a[92:93], v82 offset:36864
    v_accvgpr_write_b32 a144, v248
    v_accvgpr_write_b32 a145, v249
    v_mfma_f32_16x16x32_bf16 v[92:95], v[96:99], a[84:87], 0
    ds_read_b64_tr_b16 a[94:95], v82 offset:37632
    v_accvgpr_write_b32 a146, v250
    v_accvgpr_write_b32 a147, v251
    v_cvt_pk_bf16_f32 v240, v48, v49
    v_mfma_f32_16x16x32_bf16 v[56:59], v[24:27], v[102:105], v[56:59]
    ds_read_b128 v[40:43], v85 offset:36864
    v_cvt_pk_bf16_f32 v241, v50, v51
    v_cvt_pk_bf16_f32 v242, v52, v53
    v_mfma_f32_16x16x32_bf16 v[92:95], v[28:31], v[102:105], v[92:95]
    s_waitcnt lgkmcnt(3)
    ds_read_b128 v[44:47], v85 offset:37632
    v_cvt_pk_bf16_f32 v243, v54, v55
    v_mfma_f32_16x16x32_bf16 v[48:51], v[98:101], a[88:91], 0
    ds_read_b64_tr_b16 a[96:97], v80 offset:55296
    v_mfma_f32_16x16x32_bf16 v[52:55], v[96:99], a[88:91], 0
    ds_read_b64_tr_b16 a[98:99], v80 offset:56064
    v_cvt_pk_bf16_f32 v248, v56, v57
    v_mfma_f32_16x16x32_bf16 v[48:51], v[32:35], v[102:105], v[48:51]
    ds_read_b128 v[24:27], v83 offset:55296
    v_cvt_pk_bf16_f32 v249, v58, v59
    v_cvt_pk_bf16_f32 v250, v92, v93
    v_mfma_f32_16x16x32_bf16 v[52:55], v[36:39], v[102:105], v[52:55]
    s_waitcnt lgkmcnt(3)
    ds_read_b128 v[28:31], v83 offset:56064
    v_cvt_pk_bf16_f32 v251, v94, v95
    v_mfma_f32_16x16x32_bf16 v[56:59], v[98:101], a[92:95], 0
    ds_read_b64_tr_b16 a[100:101], v81 offset:55296
    v_accvgpr_write_b32 a148, v248
    v_accvgpr_write_b32 a149, v249
    v_mfma_f32_16x16x32_bf16 v[92:95], v[96:99], a[92:95], 0
    ds_read_b64_tr_b16 a[102:103], v81 offset:56064
    v_accvgpr_write_b32 a150, v250
    v_accvgpr_write_b32 a151, v251
    v_cvt_pk_bf16_f32 v244, v48, v49
    v_mfma_f32_16x16x32_bf16 v[56:59], v[40:43], v[102:105], v[56:59]
    ds_read_b128 v[32:35], v84 offset:55296
    v_cvt_pk_bf16_f32 v245, v50, v51
    v_cvt_pk_bf16_f32 v246, v52, v53
    v_mfma_f32_16x16x32_bf16 v[92:95], v[44:47], v[102:105], v[92:95]
    s_waitcnt lgkmcnt(3)
    ds_read_b128 v[36:39], v84 offset:56064
    v_cvt_pk_bf16_f32 v247, v54, v55
    v_mfma_f32_16x16x32_bf16 v[48:51], v[98:101], a[96:99], 0
    ds_read_b64_tr_b16 a[104:105], v82 offset:55296
    v_mfma_f32_16x16x32_bf16 v[52:55], v[96:99], a[96:99], 0
    ds_read_b64_tr_b16 a[106:107], v82 offset:56064
    v_cvt_pk_bf16_f32 v248, v56, v57
    v_mfma_f32_16x16x32_bf16 v[48:51], v[24:27], v[102:105], v[48:51]
    ds_read_b128 v[40:43], v85 offset:55296
    v_cvt_pk_bf16_f32 v249, v58, v59
    v_cvt_pk_bf16_f32 v250, v92, v93
    v_mfma_f32_16x16x32_bf16 v[52:55], v[28:31], v[102:105], v[52:55]
    s_waitcnt lgkmcnt(3)
    ds_read_b128 v[44:47], v85 offset:56064
    v_cvt_pk_bf16_f32 v251, v94, v95
    v_mfma_f32_16x16x32_bf16 v[56:59], v[98:101], a[100:103], 0
    v_accvgpr_write_b32 a152, v248
    v_accvgpr_write_b32 a153, v249
    v_mfma_f32_16x16x32_bf16 v[92:95], v[96:99], a[100:103], 0
    v_accvgpr_write_b32 a154, v250
    v_accvgpr_write_b32 a155, v251
    v_cvt_pk_bf16_f32 v248, v48, v49
    v_mfma_f32_16x16x32_bf16 v[56:59], v[32:35], v[102:105], v[56:59]
    v_cvt_pk_bf16_f32 v249, v50, v51
    v_cvt_pk_bf16_f32 v250, v52, v53
    v_mfma_f32_16x16x32_bf16 v[92:95], v[36:39], v[102:105], v[92:95]
    s_waitcnt lgkmcnt(0)
    v_cvt_pk_bf16_f32 v251, v54, v55
    v_accvgpr_write_b32 a156, v248
    v_mfma_f32_16x16x32_bf16 v[48:51], v[98:101], a[104:107], 0
    v_accvgpr_write_b32 a157, v249
    v_accvgpr_write_b32 a158, v250
    v_mfma_f32_16x16x32_bf16 v[52:55], v[96:99], a[104:107], 0
    v_accvgpr_write_b32 a159, v251
    v_cvt_pk_bf16_f32 v248, v56, v57
    v_mfma_f32_16x16x32_bf16 v[48:51], v[40:43], v[102:105], v[48:51]
    v_cvt_pk_bf16_f32 v249, v58, v59
    v_cvt_pk_bf16_f32 v250, v92, v93
    v_mfma_f32_16x16x32_bf16 v[52:55], v[44:47], v[102:105], v[52:55]
    v_cvt_pk_bf16_f32 v251, v94, v95
    v_accvgpr_write_b32 a160, v248
    s_nop 7
    v_accvgpr_write_b32 a161, v249
    v_accvgpr_write_b32 a162, v250
    v_accvgpr_write_b32 a163, v251
    v_cvt_pk_bf16_f32 v248, v48, v49
    v_cvt_pk_bf16_f32 v249, v50, v51
    v_cvt_pk_bf16_f32 v250, v52, v53
    v_cvt_pk_bf16_f32 v251, v54, v55
    v_accvgpr_write_b32 a164, v248
    v_accvgpr_write_b32 a165, v249
    v_accvgpr_write_b32 a166, v250
    v_accvgpr_write_b32 a167, v251
    s_waitcnt vmcnt(11)
    v_lshlrev_b32 v152, 16, v60
    v_and_b32 v153, s16, v60
    v_lshlrev_b32 v154, 16, v61
    v_and_b32 v155, s16, v61
    v_lshlrev_b32 v156, 16, v62
    v_and_b32 v157, s16, v62
    v_lshlrev_b32 v158, 16, v63
    v_and_b32 v159, s16, v63
    s_waitcnt vmcnt(10)
    v_lshlrev_b32 v160, 16, v64
    v_and_b32 v161, s16, v64
    v_lshlrev_b32 v162, 16, v65
    v_and_b32 v163, s16, v65
    v_lshlrev_b32 v164, 16, v66
    v_and_b32 v165, s16, v66
    v_lshlrev_b32 v166, 16, v67
    v_and_b32 v167, s16, v67
    s_waitcnt vmcnt(9)
    v_lshlrev_b32 v168, 16, v68
    v_and_b32 v169, s16, v68
    v_lshlrev_b32 v170, 16, v69
    v_and_b32 v171, s16, v69
    s_waitcnt vmcnt(8)
    v_lshlrev_b32 v172, 16, v72
    v_and_b32 v173, s16, v72
    v_lshlrev_b32 v174, 16, v73
    v_and_b32 v175, s16, v73
    v_lshlrev_b32 v176, 16, v74
    v_and_b32 v177, s16, v74
    v_lshlrev_b32 v178, 16, v75
    v_and_b32 v179, s16, v75
    s_waitcnt vmcnt(7)
    v_lshlrev_b32 v180, 16, v76
    v_and_b32 v181, s16, v76
    v_lshlrev_b32 v182, 16, v77
    v_and_b32 v183, s16, v77
    v_lshlrev_b32 v184, 16, v78
    v_and_b32 v185, s16, v78
    v_lshlrev_b32 v186, 16, v79
    v_and_b32 v187, s16, v79
    s_waitcnt vmcnt(6)
    v_lshlrev_b32 v188, 16, v70
    v_and_b32 v189, s16, v70
    v_lshlrev_b32 v190, 16, v71
    v_and_b32 v191, s16, v71
    s_add_u32 s18, s34, s100
    s_add_u32 s19, s18, s100
    s_waitcnt vmcnt(5)
    v_lshlrev_b32 v192, 16, v132
    v_and_b32 v193, s16, v132
    v_lshlrev_b32 v194, 16, v133
    v_and_b32 v195, s16, v133
    v_lshlrev_b32 v196, 16, v134
    v_and_b32 v197, s16, v134
    v_lshlrev_b32 v198, 16, v135
    v_and_b32 v199, s16, v135
    v_pk_add_f32 v[152:153], v[152:153], v[192:193] neg_lo:[0,1] neg_hi:[0,1]
    buffer_load_dwordx4 v[132:135], v1, s[12:15], s18 offen
    v_pk_add_f32 v[154:155], v[154:155], v[194:195] neg_lo:[0,1] neg_hi:[0,1]
    v_pk_add_f32 v[156:157], v[156:157], v[196:197] neg_lo:[0,1] neg_hi:[0,1]
    v_pk_add_f32 v[158:159], v[158:159], v[198:199] neg_lo:[0,1] neg_hi:[0,1]
    v_cvt_pk_bf16_f32 v108, v152, v153
    v_cvt_pk_bf16_f32 v109, v154, v155
    v_cvt_pk_bf16_f32 v110, v156, v157
    v_cvt_pk_bf16_f32 v111, v158, v159
    v_pk_add_f32 v[124:125], v[172:173], v[192:193]
    ds_write_b128 v4, v[108:111] offset:0
    v_pk_add_f32 v[126:127], v[174:175], v[194:195]
    v_pk_add_f32 v[128:129], v[176:177], v[196:197]
    v_pk_add_f32 v[130:131], v[178:179], v[198:199]
    v_cvt_pk_bf16_f32 v112, v124, v125
    v_cvt_pk_bf16_f32 v113, v126, v127
    v_cvt_pk_bf16_f32 v114, v128, v129
    v_cvt_pk_bf16_f32 v115, v130, v131
    v_pk_add_f32 v[152:153], v[172:173], v[192:193] neg_lo:[0,1] neg_hi:[0,1]
    ds_write_b128 v4, v[112:115] offset:9600
    v_pk_add_f32 v[154:155], v[174:175], v[194:195] neg_lo:[0,1] neg_hi:[0,1]
    v_pk_add_f32 v[156:157], v[176:177], v[196:197] neg_lo:[0,1] neg_hi:[0,1]
    v_pk_add_f32 v[158:159], v[178:179], v[198:199] neg_lo:[0,1] neg_hi:[0,1]
    v_cvt_pk_bf16_f32 v116, v152, v153
    v_cvt_pk_bf16_f32 v117, v154, v155
    v_cvt_pk_bf16_f32 v118, v156, v157
    v_cvt_pk_bf16_f32 v119, v158, v159
    s_waitcnt vmcnt(5)
    ds_write_b128 v4, v[116:119] offset:19200
    v_lshlrev_b32 v124, 16, v136
    v_and_b32 v125, s16, v136
    v_lshlrev_b32 v126, 16, v137
    v_and_b32 v127, s16, v137
    v_lshlrev_b32 v128, 16, v138
    v_and_b32 v129, s16, v138
    v_lshlrev_b32 v130, 16, v139
    v_and_b32 v131, s16, v139
    v_pk_add_f32 v[160:161], v[160:161], v[124:125] neg_lo:[0,1] neg_hi:[0,1]
    buffer_load_dwordx4 v[136:139], v2, s[12:15], s18 offen
    v_pk_add_f32 v[162:163], v[162:163], v[126:127] neg_lo:[0,1] neg_hi:[0,1]
    v_pk_add_f32 v[164:165], v[164:165], v[128:129] neg_lo:[0,1] neg_hi:[0,1]
    v_pk_add_f32 v[166:167], v[166:167], v[130:131] neg_lo:[0,1] neg_hi:[0,1]
    v_cvt_pk_bf16_f32 v120, v160, v161
    v_cvt_pk_bf16_f32 v121, v162, v163
    v_cvt_pk_bf16_f32 v122, v164, v165
    v_cvt_pk_bf16_f32 v123, v166, v167
    v_pk_add_f32 v[152:153], v[180:181], v[124:125]
    ds_write_b128 v5, v[120:123] offset:0
    v_pk_add_f32 v[154:155], v[182:183], v[126:127]
    v_pk_add_f32 v[156:157], v[184:185], v[128:129]
    v_pk_add_f32 v[158:159], v[186:187], v[130:131]
    v_cvt_pk_bf16_f32 v108, v152, v153
    v_cvt_pk_bf16_f32 v109, v154, v155
    v_cvt_pk_bf16_f32 v110, v156, v157
    v_cvt_pk_bf16_f32 v111, v158, v159
    v_pk_add_f32 v[160:161], v[180:181], v[124:125] neg_lo:[0,1] neg_hi:[0,1]
    ds_write_b128 v5, v[108:111] offset:9600
    v_pk_add_f32 v[162:163], v[182:183], v[126:127] neg_lo:[0,1] neg_hi:[0,1]
    v_pk_add_f32 v[164:165], v[184:185], v[128:129] neg_lo:[0,1] neg_hi:[0,1]
    v_pk_add_f32 v[166:167], v[186:187], v[130:131] neg_lo:[0,1] neg_hi:[0,1]
    v_cvt_pk_bf16_f32 v112, v160, v161
    v_cvt_pk_bf16_f32 v113, v162, v163
    v_cvt_pk_bf16_f32 v114, v164, v165
    v_cvt_pk_bf16_f32 v115, v166, v167
    s_waitcnt vmcnt(5)
    ds_write_b128 v5, v[112:115] offset:19200
    v_lshlrev_b32 v152, 16, v140
    v_and_b32 v153, s16, v140
    v_lshlrev_b32 v154, 16, v141
    v_and_b32 v155, s16, v141
    v_pk_add_f32 v[168:169], v[168:169], v[152:153] neg_lo:[0,1] neg_hi:[0,1]
    buffer_load_dwordx2 v[140:141], v3, s[12:15], s18 offen
    v_pk_add_f32 v[170:171], v[170:171], v[154:155] neg_lo:[0,1] neg_hi:[0,1]
    v_cvt_pk_bf16_f32 v116, v168, v169
    v_cvt_pk_bf16_f32 v117, v170, v171
    v_pk_add_f32 v[156:157], v[188:189], v[152:153]
    ds_write_b64 v6, v[116:117] offset:0
    v_pk_add_f32 v[158:159], v[190:191], v[154:155]
    v_cvt_pk_bf16_f32 v120, v156, v157
    v_cvt_pk_bf16_f32 v121, v158, v159
    v_pk_add_f32 v[160:161], v[188:189], v[152:153] neg_lo:[0,1] neg_hi:[0,1]
    ds_write_b64 v6, v[120:121] offset:9600
    v_pk_add_f32 v[162:163], v[190:191], v[154:155] neg_lo:[0,1] neg_hi:[0,1]
    v_cvt_pk_bf16_f32 v108, v160, v161
    v_cvt_pk_bf16_f32 v109, v162, v163
    ds_write_b64 v6, v[108:109] offset:19200
    s_waitcnt lgkmcnt(0)
    s_barrier
    s_add_u32 s18, s18, s98
    ds_read_b128 a[168:171], v10 offset:0
    ds_read_b128 a[172:175], v10 offset:192
    ds_read_b128 a[176:179], v10 offset:384
    ds_read_b128 a[180:183], v11 offset:576
    ds_read_b128 a[184:187], v11 offset:768
    s_waitcnt lgkmcnt(0)
    v_mfma_f32_16x16x32_bf16 v[24:27], v[200:203], a[168:171], 0
    v_mfma_f32_16x16x32_bf16 v[24:27], a[112:115], a[172:175], v[24:27]
    ds_read_b128 a[188:191], v10 offset:64
    v_mfma_f32_16x16x32_bf16 v[24:27], v[212:215], a[176:179], v[24:27]
    ds_read_b128 a[192:195], v10 offset:256
    v_mfma_f32_16x16x32_bf16 v[28:31], a[108:111], a[168:171], 0
    ds_read_b128 a[196:199], v10 offset:448
    v_mfma_f32_16x16x32_bf16 v[28:31], v[208:211], a[172:175], v[28:31]
    ds_read_b128 a[200:203], v11 offset:640
    v_mfma_f32_16x16x32_bf16 v[28:31], a[120:123], a[176:179], v[28:31]
    ds_read_b128 a[204:207], v11 offset:832
    v_mfma_f32_16x16x32_bf16 v[32:35], v[204:207], a[168:171], 0
    v_mfma_f32_16x16x32_bf16 v[32:35], a[116:119], a[172:175], v[32:35]
    v_mfma_f32_16x16x32_bf16 v[32:35], v[216:219], a[176:179], v[32:35]
    v_mfma_f32_16x16x32_bf16 v[36:39], v[200:203], a[172:175], 0
    v_mfma_f32_16x16x32_bf16 v[36:39], a[112:115], a[176:179], v[36:39]
    v_mfma_f32_16x16x32_bf16 v[36:39], v[212:215], a[180:183], v[36:39]
    v_mfma_f32_16x16x32_bf16 v[40:43], a[108:111], a[172:175], 0
    v_mfma_f32_16x16x32_bf16 v[40:43], v[208:211], a[176:179], v[40:43]
    v_mfma_f32_16x16x32_bf16 v[40:43], a[120:123], a[180:183], v[40:43]
    v_mfma_f32_16x16x32_bf16 v[44:47], v[204:207], a[172:175], 0
    v_mfma_f32_16x16x32_bf16 v[44:47], a[116:119], a[176:179], v[44:47]
    s_waitcnt vmcnt(5)
    v_lshlrev_b32 v164, 16, v144
    v_and_b32 v165, s16, v144
    v_mfma_f32_16x16x32_bf16 v[44:47], v[216:219], a[180:183], v[44:47]
    v_lshlrev_b32 v166, 16, v145
    v_and_b32 v167, s16, v145
    v_mfma_f32_16x16x32_bf16 v[48:51], v[200:203], a[176:179], 0
    v_lshlrev_b32 v168, 16, v146
    v_and_b32 v169, s16, v146
    v_mfma_f32_16x16x32_bf16 v[48:51], a[112:115], a[180:183], v[48:51]
    v_lshlrev_b32 v170, 16, v147
    v_and_b32 v171, s16, v147
    v_mfma_f32_16x16x32_bf16 v[48:51], v[212:215], a[184:187], v[48:51]
    buffer_load_dwordx4 v[144:147], v1, s[12:15], s19 offen
    v_sub_f32 v172, v164, v172
    v_mfma_f32_16x16x32_bf16 v[52:55], a[108:111], a[176:179], 0
    v_sub_f32 v173, v165, v173
    v_cvt_pk_bf16_f32 v112, v172, v173
    v_mfma_f32_16x16x32_bf16 v[52:55], v[208:211], a[180:183], v[52:55]
    v_sub_f32 v174, v166, v174
    v_sub_f32 v175, v167, v175
    v_mfma_f32_16x16x32_bf16 v[52:55], a[120:123], a[184:187], v[52:55]
    v_cvt_pk_bf16_f32 v113, v174, v175
    v_sub_f32 v176, v168, v176
    v_mfma_f32_16x16x32_bf16 v[56:59], v[204:207], a[176:179], 0
    v_sub_f32 v177, v169, v177
    v_cvt_pk_bf16_f32 v114, v176, v177
    v_mfma_f32_16x16x32_bf16 v[56:59], a[116:119], a[180:183], v[56:59]
    v_sub_f32 v178, v170, v178
    v_sub_f32 v179, v171, v179
    v_mfma_f32_16x16x32_bf16 v[56:59], v[216:219], a[184:187], v[56:59]
    s_waitcnt lgkmcnt(0)
    v_cvt_pk_bf16_f32 v115, v178, v179
    v_mfma_f32_16x16x32_bf16 v[24:27], a[124:127], a[188:191], v[24:27]
    s_waitcnt vmcnt(5)
    v_lshlrev_b32 v156, 16, v148
    v_and_b32 v157, s16, v148
    v_mfma_f32_16x16x32_bf16 v[24:27], v[224:227], a[192:195], v[24:27]
    ds_write_b128 v4, v[112:115] offset:28800
    v_mfma_f32_16x16x32_bf16 v[24:27], a[136:139], a[196:199], v[24:27]
    v_lshlrev_b32 v158, 16, v149
    v_and_b32 v159, s16, v149
    v_mfma_f32_16x16x32_bf16 v[28:31], v[220:223], a[188:191], v[28:31]
    v_lshlrev_b32 v160, 16, v150
    v_and_b32 v161, s16, v150
    v_mfma_f32_16x16x32_bf16 v[28:31], a[132:135], a[192:195], v[28:31]
    ds_read_b128 a[168:171], v10 offset:128
    v_lshlrev_b32 v162, 16, v151
    v_mfma_f32_16x16x32_bf16 v[28:31], v[232:235], a[196:199], v[28:31]
    ds_read_b128 a[172:175], v10 offset:320
    v_and_b32 v163, s16, v151
    v_mfma_f32_16x16x32_bf16 v[32:35], a[128:131], a[188:191], v[32:35]
    buffer_load_dwordx4 v[148:151], v2, s[12:15], s19 offen
    v_sub_f32 v180, v156, v180
    v_mfma_f32_16x16x32_bf16 v[32:35], v[228:231], a[192:195], v[32:35]
    ds_read_b128 a[176:179], v10 offset:512
    v_sub_f32 v181, v157, v181
    v_mfma_f32_16x16x32_bf16 v[32:35], a[140:143], a[196:199], v[32:35]
    ds_read_b128 a[180:183], v11 offset:704
    v_cvt_pk_bf16_f32 v116, v180, v181
    v_mfma_f32_16x16x32_bf16 v[36:39], a[124:127], a[192:195], v[36:39]
    ds_read_b128 a[184:187], v11 offset:896
    v_sub_f32 v182, v158, v182
    v_mfma_f32_16x16x32_bf16 v[36:39], v[224:227], a[196:199], v[36:39]
    v_sub_f32 v183, v159, v183
    v_cvt_pk_bf16_f32 v117, v182, v183
    v_mfma_f32_16x16x32_bf16 v[36:39], a[136:139], a[200:203], v[36:39]
    v_sub_f32 v184, v160, v184
    v_sub_f32 v185, v161, v185
    v_mfma_f32_16x16x32_bf16 v[40:43], v[220:223], a[192:195], v[40:43]
    v_cvt_pk_bf16_f32 v118, v184, v185
    v_sub_f32 v186, v162, v186
    v_mfma_f32_16x16x32_bf16 v[40:43], a[132:135], a[196:199], v[40:43]
    v_sub_f32 v187, v163, v187
    v_cvt_pk_bf16_f32 v119, v186, v187
    v_mfma_f32_16x16x32_bf16 v[40:43], v[232:235], a[200:203], v[40:43]
    s_waitcnt vmcnt(5)
    v_lshlrev_b32 v172, 16, v142
    v_and_b32 v173, s16, v142
    v_mfma_f32_16x16x32_bf16 v[44:47], a[128:131], a[192:195], v[44:47]
    ds_write_b128 v5, v[116:119] offset:28800
    v_mfma_f32_16x16x32_bf16 v[44:47], v[228:231], a[196:199], v[44:47]
    v_lshlrev_b32 v174, 16, v143
    v_and_b32 v175, s16, v143
    v_mfma_f32_16x16x32_bf16 v[44:47], a[140:143], a[200:203], v[44:47]
    buffer_load_dwordx2 v[142:143], v3, s[12:15], s19 offen
    v_sub_f32 v188, v172, v188
    v_mfma_f32_16x16x32_bf16 v[48:51], a[124:127], a[196:199], v[48:51]
    s_add_u32 s19, s19, s98
    v_sub_f32 v189, v173, v189
    v_cvt_pk_bf16_f32 v120, v188, v189
    v_mfma_f32_16x16x32_bf16 v[48:51], v[224:227], a[200:203], v[48:51]
    v_sub_f32 v190, v174, v190
    v_sub_f32 v191, v175, v191
    v_mfma_f32_16x16x32_bf16 v[48:51], a[136:139], a[204:207], v[48:51]
    v_cvt_pk_bf16_f32 v121, v190, v191
    v_mfma_f32_16x16x32_bf16 v[52:55], v[220:223], a[196:199], v[52:55]
    ds_write_b64 v6, v[120:121] offset:28800
    v_mfma_f32_16x16x32_bf16 v[52:55], a[132:135], a[200:203], v[52:55]
    v_mfma_f32_16x16x32_bf16 v[52:55], v[232:235], a[204:207], v[52:55]
    v_mfma_f32_16x16x32_bf16 v[56:59], a[128:131], a[196:199], v[56:59]
    v_mfma_f32_16x16x32_bf16 v[56:59], v[228:231], a[200:203], v[56:59]
    v_mfma_f32_16x16x32_bf16 v[56:59], a[140:143], a[204:207], v[56:59]
    s_waitcnt lgkmcnt(2)
    v_mfma_f32_16x16x32_bf16 v[24:27], v[236:239], a[168:171], v[24:27]
    v_mfma_f32_16x16x32_bf16 v[24:27], a[148:151], a[172:175], v[24:27]
    v_mfma_f32_16x16x32_bf16 v[24:27], a[156:159], a[176:179], v[24:27]
    s_waitcnt lgkmcnt(0)
    s_barrier
    v_mfma_f32_16x16x32_bf16 v[28:31], a[144:147], a[168:171], v[28:31]
    ds_read_b128 a[188:191], v12 offset:0
    v_mfma_f32_16x16x32_bf16 v[28:31], v[244:247], a[172:175], v[28:31]
    ds_read_b128 a[192:195], v12 offset:192
    v_mfma_f32_16x16x32_bf16 v[28:31], a[160:163], a[176:179], v[28:31]
    ds_read_b128 a[196:199], v12 offset:384
    v_mfma_f32_16x16x32_bf16 v[32:35], v[240:243], a[168:171], v[32:35]
L_stub1:
    s_cbranch_execz L_stub5
    ds_read_b128 a[200:203], v13 offset:576
    v_mfma_f32_16x16x32_bf16 v[32:35], a[152:155], a[172:175], v[32:35]
    ds_read_b128 a[204:207], v13 offset:768
    v_mfma_f32_16x16x32_bf16 v[32:35], a[164:167], a[176:179], v[32:35]
    ds_write_b128 v14, v[24:27] offset:0
    v_mfma_f32_16x16x32_bf16 v[36:39], v[236:239], a[172:175], v[36:39]
    v_mfma_f32_16x16x32_bf16 v[36:39], a[148:151], a[176:179], v[36:39]
    v_mfma_f32_16x16x32_bf16 v[36:39], a[156:159], a[180:183], v[36:39]
    ds_write_b128 v14, v[28:31] offset:1024
    v_mfma_f32_16x16x32_bf16 v[40:43], a[144:147], a[172:175], v[40:43]
    s_waitcnt vmcnt(5)
    v_lshlrev_b32 v176, 16, v132
    v_and_b32 v177, s16, v132
    v_mfma_f32_16x16x32_bf16 v[40:43], v[244:247], a[176:179], v[40:43]
    v_lshlrev_b32 v178, 16, v133
    v_and_b32 v179, s16, v133
    v_mfma_f32_16x16x32_bf16 v[40:43], a[160:163], a[180:183], v[40:43]
    ds_write_b128 v14, v[32:35] offset:2048
    v_mfma_f32_16x16x32_bf16 v[44:47], v[240:243], a[172:175], v[44:47]
    v_lshlrev_b32 v180, 16, v134
    v_and_b32 v181, s16, v134
    v_mfma_f32_16x16x32_bf16 v[44:47], a[152:155], a[176:179], v[44:47]
    v_lshlrev_b32 v182, 16, v135
    v_and_b32 v183, s16, v135
    v_mfma_f32_16x16x32_bf16 v[44:47], a[164:167], a[180:183], v[44:47]
    buffer_load_dwordx4 v[132:135], v1, s[12:15], s18 offen
    v_sub_f32 v192, v192, v176
    v_mfma_f32_16x16x32_bf16 v[48:51], v[236:239], a[176:179], v[48:51]
    ds_write_b128 v14, v[36:39] offset:3072
    v_mfma_f32_16x16x32_bf16 v[48:51], a[148:151], a[180:183], v[48:51]
    v_sub_f32 v193, v193, v177
    v_cvt_pk_bf16_f32 v108, v192, v193
    v_mfma_f32_16x16x32_bf16 v[48:51], a[156:159], a[184:187], v[48:51]
    v_sub_f32 v194, v194, v178
    v_sub_f32 v195, v195, v179
    v_mfma_f32_16x16x32_bf16 v[52:55], a[144:147], a[176:179], v[52:55]
    ds_write_b128 v14, v[40:43] offset:4096
    v_mfma_f32_16x16x32_bf16 v[52:55], v[244:247], a[180:183], v[52:55]
    v_cvt_pk_bf16_f32 v109, v194, v195
    v_sub_f32 v196, v196, v180
    v_mfma_f32_16x16x32_bf16 v[52:55], a[160:163], a[184:187], v[52:55]
    v_sub_f32 v197, v197, v181
    v_cvt_pk_bf16_f32 v110, v196, v197
    v_mfma_f32_16x16x32_bf16 v[56:59], v[240:243], a[176:179], v[56:59]
    ds_write_b128 v14, v[44:47] offset:5120
    v_mfma_f32_16x16x32_bf16 v[56:59], a[152:155], a[180:183], v[56:59]
    v_sub_f32 v198, v198, v182
    v_sub_f32 v199, v199, v183
    v_mfma_f32_16x16x32_bf16 v[56:59], a[164:167], a[184:187], v[56:59]
    s_waitcnt lgkmcnt(6)
    v_cvt_pk_bf16_f32 v111, v198, v199
    v_add_f32 v184, v164, v176
    v_mfma_f32_16x16x32_bf16 v[60:63], a[0:3], a[188:191], v[24:27]
    ds_write_b128 v7, v[108:111] offset:0
    v_mfma_f32_16x16x32_bf16 v[60:63], a[12:15], a[192:195], v[60:63]
    v_add_f32 v185, v165, v177
    v_cvt_pk_bf16_f32 v112, v184, v185
    v_mfma_f32_16x16x32_bf16 v[60:63], a[24:27], a[196:199], v[60:63]
    v_add_f32 v186, v166, v178
    v_add_f32 v187, v167, v179
    v_mfma_f32_16x16x32_bf16 v[64:67], a[4:7], a[188:191], v[28:31]
    ds_read_b128 a[168:171], v12 offset:64
    v_cvt_pk_bf16_f32 v113, v186, v187
    v_mfma_f32_16x16x32_bf16 v[64:67], a[16:19], a[192:195], v[64:67]
    ds_read_b128 a[172:175], v12 offset:256
    v_add_f32 v188, v168, v180
    v_mfma_f32_16x16x32_bf16 v[64:67], a[28:31], a[196:199], v[64:67]
    ds_read_b128 a[176:179], v12 offset:448
    v_add_f32 v189, v169, v181
    v_mfma_f32_16x16x32_bf16 v[68:71], a[8:11], a[188:191], v[32:35]
    ds_read_b128 a[180:183], v13 offset:640
    v_cvt_pk_bf16_f32 v114, v188, v189
    v_mfma_f32_16x16x32_bf16 v[68:71], a[20:23], a[192:195], v[68:71]
    ds_read_b128 a[184:187], v13 offset:832
    v_add_f32 v190, v170, v182
    v_mfma_f32_16x16x32_bf16 v[68:71], a[32:35], a[196:199], v[68:71]
    ds_write_b128 v14, v[48:51] offset:6144
    v_mfma_f32_16x16x32_bf16 v[72:75], a[0:3], a[192:195], v[36:39]
    v_add_f32 v191, v171, v183
    v_cvt_pk_bf16_f32 v115, v190, v191
    v_mfma_f32_16x16x32_bf16 v[72:75], a[12:15], a[196:199], v[72:75]
    v_sub_f32 v192, v164, v176
    v_sub_f32 v193, v165, v177
    v_mfma_f32_16x16x32_bf16 v[72:75], a[24:27], a[200:203], v[72:75]
    ds_write_b128 v7, v[112:115] offset:9600
    v_mfma_f32_16x16x32_bf16 v[76:79], a[4:7], a[192:195], v[40:43]
    v_cvt_pk_bf16_f32 v116, v192, v193
    v_sub_f32 v194, v166, v178
    v_mfma_f32_16x16x32_bf16 v[76:79], a[16:19], a[196:199], v[76:79]
    v_sub_f32 v195, v167, v179
    v_cvt_pk_bf16_f32 v117, v194, v195
    v_mfma_f32_16x16x32_bf16 v[76:79], a[28:31], a[200:203], v[76:79]
    ds_write_b128 v14, v[52:55] offset:7168
    v_mfma_f32_16x16x32_bf16 v[80:83], a[8:11], a[192:195], v[44:47]
    v_sub_f32 v196, v168, v180
    v_sub_f32 v197, v169, v181
    v_mfma_f32_16x16x32_bf16 v[80:83], a[20:23], a[196:199], v[80:83]
    v_cvt_pk_bf16_f32 v118, v196, v197
    v_sub_f32 v198, v170, v182
    v_mfma_f32_16x16x32_bf16 v[80:83], a[32:35], a[200:203], v[80:83]
    ds_write_b128 v14, v[56:59] offset:8192
    v_mfma_f32_16x16x32_bf16 v[84:87], a[0:3], a[196:199], v[48:51]
    v_sub_f32 v199, v171, v183
    v_cvt_pk_bf16_f32 v119, v198, v199
    v_mfma_f32_16x16x32_bf16 v[84:87], a[12:15], a[200:203], v[84:87]
    s_waitcnt vmcnt(5)
    v_lshlrev_b32 v184, 16, v136
    v_and_b32 v185, s16, v136
    v_mfma_f32_16x16x32_bf16 v[84:87], a[24:27], a[204:207], v[84:87]
    ds_write_b128 v7, v[116:119] offset:19200
    v_mfma_f32_16x16x32_bf16 v[88:91], a[4:7], a[196:199], v[52:55]
    v_lshlrev_b32 v186, 16, v137
    v_and_b32 v187, s16, v137
    v_mfma_f32_16x16x32_bf16 v[88:91], a[16:19], a[200:203], v[88:91]
    v_lshlrev_b32 v188, 16, v138
    v_and_b32 v189, s16, v138
    v_mfma_f32_16x16x32_bf16 v[88:91], a[28:31], a[204:207], v[88:91]
    v_lshlrev_b32 v190, 16, v139
    v_and_b32 v191, s16, v139
    v_mfma_f32_16x16x32_bf16 v[92:95], a[8:11], a[196:199], v[56:59]
    buffer_load_dwordx4 v[136:139], v2, s[12:15], s18 offen
    v_sub_f32 v124, v124, v184
    v_mfma_f32_16x16x32_bf16 v[92:95], a[20:23], a[200:203], v[92:95]
    v_sub_f32 v125, v125, v185
    v_cvt_pk_bf16_f32 v120, v124, v125
    v_mfma_f32_16x16x32_bf16 v[92:95], a[32:35], a[204:207], v[92:95]
    s_waitcnt lgkmcnt(5)
    v_sub_f32 v126, v126, v186
    v_sub_f32 v127, v127, v187
    v_mfma_f32_16x16x32_bf16 v[60:63], a[36:39], a[168:171], v[60:63]
    v_cvt_pk_bf16_f32 v121, v126, v127
    v_sub_f32 v128, v128, v188
    v_mfma_f32_16x16x32_bf16 v[60:63], a[48:51], a[172:175], v[60:63]
    ds_read_b128 a[188:191], v12 offset:128
    v_sub_f32 v129, v129, v189
    v_mfma_f32_16x16x32_bf16 v[60:63], a[60:63], a[176:179], v[60:63]
    ds_read_b128 a[192:195], v12 offset:320
    v_cvt_pk_bf16_f32 v122, v128, v129
    v_mfma_f32_16x16x32_bf16 v[64:67], a[40:43], a[168:171], v[64:67]
    ds_read_b128 a[196:199], v12 offset:512
    v_sub_f32 v130, v130, v190
    v_mfma_f32_16x16x32_bf16 v[64:67], a[52:55], a[172:175], v[64:67]
    ds_read_b128 a[200:203], v13 offset:704
    v_sub_f32 v131, v131, v191
    v_mfma_f32_16x16x32_bf16 v[64:67], a[64:67], a[176:179], v[64:67]
    ds_read_b128 a[204:207], v13 offset:896
    v_cvt_pk_bf16_f32 v123, v130, v131
    v_mfma_f32_16x16x32_bf16 v[68:71], a[44:47], a[168:171], v[68:71]
    ds_write_b128 v8, v[120:123] offset:0
    v_mfma_f32_16x16x32_bf16 v[68:71], a[56:59], a[172:175], v[68:71]
    v_add_f32 v192, v156, v184
    v_add_f32 v193, v157, v185
    v_mfma_f32_16x16x32_bf16 v[68:71], a[68:71], a[176:179], v[68:71]
    v_cvt_pk_bf16_f32 v108, v192, v193
    v_add_f32 v194, v158, v186
    v_mfma_f32_16x16x32_bf16 v[72:75], a[36:39], a[172:175], v[72:75]
    v_add_f32 v195, v159, v187
    v_cvt_pk_bf16_f32 v109, v194, v195
    v_mfma_f32_16x16x32_bf16 v[72:75], a[48:51], a[176:179], v[72:75]
    v_add_f32 v196, v160, v188
    v_add_f32 v197, v161, v189
    v_mfma_f32_16x16x32_bf16 v[72:75], a[60:63], a[180:183], v[72:75]
    v_cvt_pk_bf16_f32 v110, v196, v197
    v_add_f32 v198, v162, v190
    v_mfma_f32_16x16x32_bf16 v[76:79], a[40:43], a[172:175], v[76:79]
    v_add_f32 v199, v163, v191
    v_cvt_pk_bf16_f32 v111, v198, v199
    v_mfma_f32_16x16x32_bf16 v[76:79], a[52:55], a[176:179], v[76:79]
    ds_write_b128 v8, v[108:111] offset:9600
    v_mfma_f32_16x16x32_bf16 v[76:79], a[64:67], a[180:183], v[76:79]
    v_sub_f32 v124, v156, v184
    v_sub_f32 v125, v157, v185
    v_mfma_f32_16x16x32_bf16 v[80:83], a[44:47], a[172:175], v[80:83]
    v_cvt_pk_bf16_f32 v112, v124, v125
    v_sub_f32 v126, v158, v186
    v_mfma_f32_16x16x32_bf16 v[80:83], a[56:59], a[176:179], v[80:83]
    v_sub_f32 v127, v159, v187
    v_cvt_pk_bf16_f32 v113, v126, v127
    v_mfma_f32_16x16x32_bf16 v[80:83], a[68:71], a[180:183], v[80:83]
    v_sub_f32 v128, v160, v188
    v_sub_f32 v129, v161, v189
    v_mfma_f32_16x16x32_bf16 v[84:87], a[36:39], a[176:179], v[84:87]
    v_cvt_pk_bf16_f32 v114, v128, v129
    v_sub_f32 v130, v162, v190
    v_mfma_f32_16x16x32_bf16 v[84:87], a[48:51], a[180:183], v[84:87]
    v_sub_f32 v131, v163, v191
    v_cvt_pk_bf16_f32 v115, v130, v131
    v_mfma_f32_16x16x32_bf16 v[84:87], a[60:63], a[184:187], v[84:87]
    s_waitcnt vmcnt(5)
    v_lshlrev_b32 v192, 16, v140
    v_and_b32 v193, s16, v140
    v_mfma_f32_16x16x32_bf16 v[88:91], a[40:43], a[176:179], v[88:91]
    ds_write_b128 v8, v[112:115] offset:19200
    v_mfma_f32_16x16x32_bf16 v[88:91], a[52:55], a[180:183], v[88:91]
    v_lshlrev_b32 v194, 16, v141
    v_and_b32 v195, s16, v141
    v_mfma_f32_16x16x32_bf16 v[88:91], a[64:67], a[184:187], v[88:91]
    buffer_load_dwordx2 v[140:141], v3, s[12:15], s18 offen
    v_sub_f32 v152, v152, v192
    v_mfma_f32_16x16x32_bf16 v[92:95], a[44:47], a[176:179], v[92:95]
    s_add_u32 s18, s18, s98
    v_sub_f32 v153, v153, v193
    v_cvt_pk_bf16_f32 v116, v152, v153
    v_mfma_f32_16x16x32_bf16 v[92:95], a[56:59], a[180:183], v[92:95]
    v_sub_f32 v154, v154, v194
    v_sub_f32 v155, v155, v195
    v_mfma_f32_16x16x32_bf16 v[92:95], a[68:71], a[184:187], v[92:95]
    s_waitcnt lgkmcnt(3)
    v_cvt_pk_bf16_f32 v117, v154, v155
    v_add_f32 v196, v172, v192
    v_mfma_f32_16x16x32_bf16 v[60:63], a[72:75], a[188:191], v[60:63]
    ds_write_b64 v9, v[116:117] offset:0
    v_add_f32 v197, v173, v193
    v_cvt_pk_bf16_f32 v120, v196, v197
    v_mfma_f32_16x16x32_bf16 v[60:63], a[84:87], a[192:195], v[60:63]
    v_add_f32 v198, v174, v194
    v_add_f32 v199, v175, v195
    v_mfma_f32_16x16x32_bf16 v[60:63], a[96:99], a[196:199], v[60:63]
    v_cvt_pk_bf16_f32 v121, v198, v199
    v_sub_f32 v124, v172, v192
    v_mfma_f32_16x16x32_bf16 v[64:67], a[76:79], a[188:191], v[64:67]
    ds_write_b64 v9, v[120:121] offset:9600
    v_sub_f32 v125, v173, v193
    v_cvt_pk_bf16_f32 v108, v124, v125
    v_mfma_f32_16x16x32_bf16 v[64:67], a[88:91], a[192:195], v[64:67]
    v_sub_f32 v126, v174, v194
    v_sub_f32 v127, v175, v195
    v_cvt_pk_bf16_f32 v109, v126, v127
    v_mfma_f32_16x16x32_bf16 v[64:67], a[100:103], a[196:199], v[64:67]
    s_waitcnt vmcnt(5)
    v_lshlrev_b32 v128, 16, v144
    v_and_b32 v129, s16, v144
    v_mfma_f32_16x16x32_bf16 v[68:71], a[80:83], a[188:191], v[68:71]
    ds_write_b64 v9, v[108:109] offset:19200
    v_mfma_f32_16x16x32_bf16 v[68:71], a[92:95], a[192:195], v[68:71]
    v_lshlrev_b32 v130, 16, v145
    v_and_b32 v131, s16, v145
    v_mfma_f32_16x16x32_bf16 v[68:71], a[104:107], a[196:199], v[68:71]
    v_lshlrev_b32 v152, 16, v146
    v_and_b32 v153, s16, v146
    v_mfma_f32_16x16x32_bf16 v[72:75], a[72:75], a[192:195], v[72:75]
    v_lshlrev_b32 v154, 16, v147
    v_and_b32 v155, s16, v147
    v_mfma_f32_16x16x32_bf16 v[72:75], a[84:87], a[196:199], v[72:75]
    buffer_load_dwordx4 v[144:147], v1, s[12:15], s19 offen
    v_sub_f32 v164, v128, v164
    v_mfma_f32_16x16x32_bf16 v[72:75], a[96:99], a[200:203], v[72:75]
    s_waitcnt lgkmcnt(0)
    s_barrier
    v_sub_f32 v165, v129, v165
    v_mfma_f32_16x16x32_bf16 v[76:79], a[76:79], a[192:195], v[76:79]
    ds_read_b128 v[96:99], v15 offset:0
    v_cvt_pk_bf16_f32 v112, v164, v165
    v_mfma_f32_16x16x32_bf16 v[76:79], a[88:91], a[196:199], v[76:79]
    ds_read_b128 a[168:171], v10 offset:38400
    v_sub_f32 v166, v130, v166
    v_mfma_f32_16x16x32_bf16 v[76:79], a[100:103], a[200:203], v[76:79]
    ds_read_b128 a[172:175], v10 offset:38592
    v_sub_f32 v167, v131, v167
    v_mfma_f32_16x16x32_bf16 v[80:83], a[80:83], a[192:195], v[80:83]
    ds_read_b128 a[176:179], v10 offset:38784
    v_cvt_pk_bf16_f32 v113, v166, v167
    v_mfma_f32_16x16x32_bf16 v[80:83], a[92:95], a[196:199], v[80:83]
    ds_read_b128 a[180:183], v11 offset:38976
    v_sub_f32 v168, v152, v168
    v_mfma_f32_16x16x32_bf16 v[80:83], a[104:107], a[200:203], v[80:83]
    ds_read_b128 a[184:187], v11 offset:39168
    v_sub_f32 v169, v153, v169
    v_mfma_f32_16x16x32_bf16 v[84:87], a[72:75], a[196:199], v[84:87]
    ds_read_b128 v[100:103], v15 offset:1024
    v_cvt_pk_bf16_f32 v114, v168, v169
    v_mfma_f32_16x16x32_bf16 v[84:87], a[84:87], a[200:203], v[84:87]
    ds_read_b128 v[104:107], v15 offset:2048
    v_sub_f32 v170, v154, v170
    v_mfma_f32_16x16x32_bf16 v[84:87], a[96:99], a[204:207], v[84:87]
    v_sub_f32 v171, v155, v171
    v_cvt_pk_bf16_f32 v115, v170, v171
    v_mfma_f32_16x16x32_bf16 v[88:91], a[76:79], a[196:199], v[88:91]
    s_waitcnt vmcnt(5)
    v_lshlrev_b32 v196, 16, v148
    v_and_b32 v197, s16, v148
    v_mfma_f32_16x16x32_bf16 v[88:91], a[88:91], a[200:203], v[88:91]
    s_waitcnt lgkmcnt(7)
    v_fma_f32 v60, v96, s17, v60
    v_fma_f32 v61, v97, s17, v61
    v_mfma_f32_16x16x32_bf16 v[88:91], a[100:103], a[204:207], v[88:91]
    ds_write_b128 v7, v[112:115] offset:28800
    v_mfma_f32_16x16x32_bf16 v[92:95], a[80:83], a[196:199], v[92:95]
    v_fma_f32 v62, v98, s17, v62
    v_fma_f32 v63, v99, s17, v63
    v_mfma_f32_16x16x32_bf16 v[92:95], a[92:95], a[200:203], v[92:95]
    v_cvt_pk_bf16_f32 v60, v60, v61
    v_cvt_pk_bf16_f32 v61, v62, v63
    v_mfma_f32_16x16x32_bf16 v[92:95], a[104:107], a[204:207], v[92:95]
    s_waitcnt lgkmcnt(3)
    v_lshlrev_b32 v198, 16, v149
    v_and_b32 v199, s16, v149
    v_mfma_f32_16x16x32_bf16 v[24:27], v[200:203], a[168:171], 0
    ds_read_b128 v[96:99], v15 offset:3072
    v_lshlrev_b32 v124, 16, v150
    v_mfma_f32_16x16x32_bf16 v[24:27], a[112:115], a[172:175], v[24:27]
    s_waitcnt lgkmcnt(3)
    v_fma_f32 v64, v100, s17, v64
    v_fma_f32 v65, v101, s17, v65
    v_mfma_f32_16x16x32_bf16 v[24:27], v[212:215], a[176:179], v[24:27]
    ds_read_b128 a[188:191], v10 offset:38464
    v_fma_f32 v66, v102, s17, v66
    v_mfma_f32_16x16x32_bf16 v[28:31], a[108:111], a[168:171], 0
    ds_read_b128 a[192:195], v10 offset:38656
    v_fma_f32 v67, v103, s17, v67
    v_mfma_f32_16x16x32_bf16 v[28:31], v[208:211], a[172:175], v[28:31]
    ds_read_b128 v[100:103], v15 offset:4096
    v_cvt_pk_bf16_f32 v64, v64, v65
    v_mfma_f32_16x16x32_bf16 v[28:31], a[120:123], a[176:179], v[28:31]
    ds_read_b128 a[196:199], v10 offset:38848
    v_cvt_pk_bf16_f32 v65, v66, v67
    v_mfma_f32_16x16x32_bf16 v[32:35], v[204:207], a[168:171], 0
    s_waitcnt lgkmcnt(6)
    v_fma_f32 v68, v104, s17, v68
    v_fma_f32 v69, v105, s17, v69
    v_mfma_f32_16x16x32_bf16 v[32:35], a[116:119], a[172:175], v[32:35]
    ds_write2_b64 v16, v[60:61], v[64:65] offset0:0 offset1:4
    v_mfma_f32_16x16x32_bf16 v[32:35], v[216:219], a[176:179], v[32:35]
    v_fma_f32 v70, v106, s17, v70
    v_fma_f32 v71, v107, s17, v71
    v_mfma_f32_16x16x32_bf16 v[36:39], v[200:203], a[172:175], 0
    v_cvt_pk_bf16_f32 v68, v68, v69
    v_cvt_pk_bf16_f32 v69, v70, v71
    v_mfma_f32_16x16x32_bf16 v[36:39], a[112:115], a[176:179], v[36:39]
    s_waitcnt lgkmcnt(5)
    v_and_b32 v125, s16, v150
    v_fma_f32 v72, v96, s17, v72
    v_mfma_f32_16x16x32_bf16 v[36:39], v[212:215], a[180:183], v[36:39]
    ds_read_b128 v[104:107], v15 offset:5120
    v_lshlrev_b32 v126, 16, v151
    v_mfma_f32_16x16x32_bf16 v[40:43], a[108:111], a[172:175], 0
    ds_read_b128 a[200:203], v11 offset:39040
    v_fma_f32 v73, v97, s17, v73
    v_mfma_f32_16x16x32_bf16 v[40:43], v[208:211], a[176:179], v[40:43]
    ds_read_b128 a[204:207], v11 offset:39232
    v_and_b32 v127, s16, v151
    v_mfma_f32_16x16x32_bf16 v[40:43], a[120:123], a[180:183], v[40:43]
    buffer_load_dwordx4 v[148:151], v2, s[12:15], s19 offen
    v_fma_f32 v74, v98, s17, v74
    v_mfma_f32_16x16x32_bf16 v[44:47], v[204:207], a[172:175], 0
    v_fma_f32 v75, v99, s17, v75
    v_sub_f32 v156, v196, v156
    v_mfma_f32_16x16x32_bf16 v[44:47], a[116:119], a[176:179], v[44:47]
    ds_read_b128 v[96:99], v15 offset:6144
    v_cvt_pk_bf16_f32 v72, v72, v73
    v_mfma_f32_16x16x32_bf16 v[44:47], v[216:219], a[180:183], v[44:47]
    v_sub_f32 v157, v197, v157
    v_cvt_pk_bf16_f32 v73, v74, v75
    v_mfma_f32_16x16x32_bf16 v[48:51], v[200:203], a[176:179], 0
    s_waitcnt lgkmcnt(6)
    v_cvt_pk_bf16_f32 v116, v156, v157
    v_fma_f32 v76, v100, s17, v76
    v_mfma_f32_16x16x32_bf16 v[48:51], a[112:115], a[180:183], v[48:51]
    ds_write2_b64 v16, v[68:69], v[72:73] offset0:8 offset1:24
    v_mfma_f32_16x16x32_bf16 v[48:51], v[212:215], a[184:187], v[48:51]
    v_fma_f32 v77, v101, s17, v77
    v_sub_f32 v158, v198, v158
    v_mfma_f32_16x16x32_bf16 v[52:55], a[108:111], a[176:179], 0
    v_fma_f32 v78, v102, s17, v78
    v_sub_f32 v159, v199, v159
    v_mfma_f32_16x16x32_bf16 v[52:55], v[208:211], a[180:183], v[52:55]
    v_fma_f32 v79, v103, s17, v79
    v_cvt_pk_bf16_f32 v76, v76, v77
    v_mfma_f32_16x16x32_bf16 v[52:55], a[120:123], a[184:187], v[52:55]
    ds_read_b128 v[100:103], v15 offset:7168
    v_cvt_pk_bf16_f32 v117, v158, v159
    v_mfma_f32_16x16x32_bf16 v[56:59], v[204:207], a[176:179], 0
    v_cvt_pk_bf16_f32 v77, v78, v79
    v_sub_f32 v160, v124, v160
    v_mfma_f32_16x16x32_bf16 v[56:59], a[116:119], a[180:183], v[56:59]
    s_waitcnt lgkmcnt(5)
    v_fma_f32 v80, v104, s17, v80
    v_sub_f32 v161, v125, v161
    v_mfma_f32_16x16x32_bf16 v[56:59], v[216:219], a[184:187], v[56:59]
    s_waitcnt lgkmcnt(3)
    v_fma_f32 v81, v105, s17, v81
    v_fma_f32 v82, v106, s17, v82
    v_mfma_f32_16x16x32_bf16 v[24:27], a[124:127], a[188:191], v[24:27]
    v_cvt_pk_bf16_f32 v118, v160, v161
    v_fma_f32 v83, v107, s17, v83
    v_mfma_f32_16x16x32_bf16 v[24:27], v[224:227], a[192:195], v[24:27]
    ds_read_b128 v[104:107], v15 offset:8192
    v_sub_f32 v162, v126, v162
    v_mfma_f32_16x16x32_bf16 v[24:27], a[136:139], a[196:199], v[24:27]
    ds_read_b128 a[168:171], v10 offset:38528
    v_cvt_pk_bf16_f32 v80, v80, v81
    v_mfma_f32_16x16x32_bf16 v[28:31], v[220:223], a[188:191], v[28:31]
    ds_read_b128 a[172:175], v10 offset:38720
    v_cvt_pk_bf16_f32 v81, v82, v83
    v_mfma_f32_16x16x32_bf16 v[28:31], a[132:135], a[192:195], v[28:31]
    s_waitcnt lgkmcnt(5)
    v_sub_f32 v163, v127, v163
    v_fma_f32 v84, v96, s17, v84
    v_mfma_f32_16x16x32_bf16 v[28:31], v[232:235], a[196:199], v[28:31]
    ds_write2_b64 v16, v[76:77], v[80:81] offset0:28 offset1:32
    v_mfma_f32_16x16x32_bf16 v[32:35], a[128:131], a[188:191], v[32:35]
    v_cvt_pk_bf16_f32 v119, v162, v163
    v_fma_f32 v85, v97, s17, v85
    v_mfma_f32_16x16x32_bf16 v[32:35], v[228:231], a[192:195], v[32:35]
    s_waitcnt vmcnt(5)
    v_fma_f32 v86, v98, s17, v86
    v_fma_f32 v87, v99, s17, v87
    v_mfma_f32_16x16x32_bf16 v[32:35], a[140:143], a[196:199], v[32:35]
    ds_write_b128 v8, v[116:119] offset:28800
    v_mfma_f32_16x16x32_bf16 v[36:39], a[124:127], a[192:195], v[36:39]
    v_lshlrev_b32 v164, 16, v142
    v_cvt_pk_bf16_f32 v84, v84, v85
    v_mfma_f32_16x16x32_bf16 v[36:39], v[224:227], a[196:199], v[36:39]
    v_and_b32 v165, s16, v142
    v_cvt_pk_bf16_f32 v85, v86, v87
    v_mfma_f32_16x16x32_bf16 v[36:39], a[136:139], a[200:203], v[36:39]
    s_waitcnt lgkmcnt(5)
    v_lshlrev_b32 v166, 16, v143
    v_fma_f32 v88, v100, s17, v88
    v_mfma_f32_16x16x32_bf16 v[40:43], v[220:223], a[192:195], v[40:43]
    ds_read_b128 a[176:179], v10 offset:38912
    v_fma_f32 v89, v101, s17, v89
    v_mfma_f32_16x16x32_bf16 v[40:43], a[132:135], a[196:199], v[40:43]
    ds_read_b128 a[180:183], v11 offset:39104
    v_and_b32 v167, s16, v143
    v_mfma_f32_16x16x32_bf16 v[40:43], v[232:235], a[200:203], v[40:43]
    ds_read_b128 a[184:187], v11 offset:39296
    v_fma_f32 v90, v102, s17, v90
    v_mfma_f32_16x16x32_bf16 v[44:47], a[128:131], a[192:195], v[44:47]
    buffer_load_dwordx2 v[142:143], v3, s[12:15], s19 offen
    v_sub_f32 v172, v164, v172
    v_mfma_f32_16x16x32_bf16 v[44:47], v[228:231], a[196:199], v[44:47]
    s_add_u32 s19, s19, s98
    v_fma_f32 v91, v103, s17, v91
    v_cvt_pk_bf16_f32 v88, v88, v89
    v_mfma_f32_16x16x32_bf16 v[44:47], a[140:143], a[200:203], v[44:47]
    v_sub_f32 v173, v165, v173
    v_cvt_pk_bf16_f32 v89, v90, v91
    v_mfma_f32_16x16x32_bf16 v[48:51], a[124:127], a[196:199], v[48:51]
    s_waitcnt lgkmcnt(7)
    v_cvt_pk_bf16_f32 v120, v172, v173
    v_fma_f32 v92, v104, s17, v92
    v_mfma_f32_16x16x32_bf16 v[48:51], v[224:227], a[200:203], v[48:51]
    ds_write2_b64 v16, v[84:85], v[88:89] offset0:48 offset1:52
    v_mfma_f32_16x16x32_bf16 v[48:51], a[136:139], a[204:207], v[48:51]
    v_sub_f32 v174, v166, v174
    v_fma_f32 v93, v105, s17, v93
    v_mfma_f32_16x16x32_bf16 v[52:55], v[220:223], a[196:199], v[52:55]
    v_fma_f32 v94, v106, s17, v94
    v_sub_f32 v175, v167, v175
    v_mfma_f32_16x16x32_bf16 v[52:55], a[132:135], a[200:203], v[52:55]
    v_fma_f32 v95, v107, s17, v95
    v_cvt_pk_bf16_f32 v121, v174, v175
    v_mfma_f32_16x16x32_bf16 v[52:55], v[232:235], a[204:207], v[52:55]
    ds_write_b64 v9, v[120:121] offset:28800
    v_cvt_pk_bf16_f32 v92, v92, v93
    v_cvt_pk_bf16_f32 v93, v94, v95
    v_mfma_f32_16x16x32_bf16 v[56:59], a[128:131], a[196:199], v[56:59]
    s_waitcnt vmcnt(5)
    v_lshlrev_b32 v168, 16, v132
    v_and_b32 v169, s16, v132
    v_mfma_f32_16x16x32_bf16 v[56:59], v[228:231], a[200:203], v[56:59]
    v_lshlrev_b32 v170, 16, v133
    v_and_b32 v171, s16, v133
    v_mfma_f32_16x16x32_bf16 v[56:59], a[140:143], a[204:207], v[56:59]
    s_waitcnt lgkmcnt(2)
    ds_write_b64 v16, v[92:93] offset:448
    v_mfma_f32_16x16x32_bf16 v[24:27], v[236:239], a[168:171], v[24:27]
    v_lshlrev_b32 v156, 16, v134
    v_and_b32 v157, s16, v134
    v_mfma_f32_16x16x32_bf16 v[24:27], a[148:151], a[172:175], v[24:27]
    v_lshlrev_b32 v158, 16, v135
    v_and_b32 v159, s16, v135
    v_mfma_f32_16x16x32_bf16 v[24:27], a[156:159], a[176:179], v[24:27]
    buffer_load_dwordx4 v[132:135], v1, s[12:15], s18 offen
    v_sub_f32 v176, v176, v168
    v_mfma_f32_16x16x32_bf16 v[28:31], a[144:147], a[168:171], v[28:31]
    s_waitcnt lgkmcnt(0)
    s_barrier
    v_sub_f32 v177, v177, v169
    v_mfma_f32_16x16x32_bf16 v[28:31], v[244:247], a[172:175], v[28:31]
    ds_read_b128 a[208:211], v17
    v_cvt_pk_bf16_f32 v108, v176, v177
    v_mfma_f32_16x16x32_bf16 v[28:31], a[160:163], a[176:179], v[28:31]
    ds_read_b128 a[212:215], v18
    v_sub_f32 v178, v178, v170
    v_mfma_f32_16x16x32_bf16 v[32:35], v[240:243], a[168:171], v[32:35]
    ds_read_b128 a[188:191], v12 offset:38400
    v_sub_f32 v179, v179, v171
    v_mfma_f32_16x16x32_bf16 v[32:35], a[152:155], a[172:175], v[32:35]
    ds_read_b128 a[192:195], v12 offset:38592
    v_cvt_pk_bf16_f32 v109, v178, v179
    v_mfma_f32_16x16x32_bf16 v[32:35], a[164:167], a[176:179], v[32:35]
    ds_read_b128 a[216:219], v19
    v_sub_f32 v180, v180, v156
    v_mfma_f32_16x16x32_bf16 v[36:39], v[236:239], a[172:175], v[36:39]
    ds_read_b128 a[196:199], v12 offset:38784
    v_sub_f32 v181, v181, v157
    v_mfma_f32_16x16x32_bf16 v[36:39], a[148:151], a[176:179], v[36:39]
    ds_read_b128 a[200:203], v13 offset:38976
    v_cvt_pk_bf16_f32 v110, v180, v181
    v_mfma_f32_16x16x32_bf16 v[36:39], a[156:159], a[180:183], v[36:39]
    ds_read_b128 a[204:207], v13 offset:39168
    v_sub_f32 v182, v182, v158
    v_mfma_f32_16x16x32_bf16 v[40:43], a[144:147], a[172:175], v[40:43]
    ds_read_b128 a[220:223], v20
    v_sub_f32 v183, v183, v159
    v_mfma_f32_16x16x32_bf16 v[40:43], v[244:247], a[176:179], v[40:43]
    ds_read_b128 a[224:227], v21
    v_cvt_pk_bf16_f32 v111, v182, v183
    v_mfma_f32_16x16x32_bf16 v[40:43], a[160:163], a[180:183], v[40:43]
    s_waitcnt lgkmcnt(9)
    v_add_f32 v160, v128, v168
    v_add_f32 v161, v129, v169
    v_mfma_f32_16x16x32_bf16 v[44:47], v[240:243], a[172:175], v[44:47]
    s_waitcnt lgkmcnt(8)
    v_cvt_pk_bf16_f32 v112, v160, v161
    v_add_f32 v162, v130, v170
    v_mfma_f32_16x16x32_bf16 v[44:47], a[152:155], a[176:179], v[44:47]
    ds_write_b128 v14, v[24:27] offset:0
    v_mfma_f32_16x16x32_bf16 v[44:47], a[164:167], a[180:183], v[44:47]
    s_waitcnt lgkmcnt(6)
    v_add_f32 v163, v131, v171
    v_cvt_pk_bf16_f32 v113, v162, v163
    v_mfma_f32_16x16x32_bf16 v[48:51], v[236:239], a[176:179], v[48:51]
    buffer_store_dwordx4 a[208:211], v22, s[24:27], s38 offen offset:0 sc0 sc1
    v_mfma_f32_16x16x32_bf16 v[48:51], a[148:151], a[180:183], v[48:51]
    ds_write_b128 v14, v[28:31] offset:1024
    v_mfma_f32_16x16x32_bf16 v[48:51], a[156:159], a[184:187], v[48:51]
    v_add_f32 v172, v152, v156
    v_add_f32 v173, v153, v157
    v_mfma_f32_16x16x32_bf16 v[52:55], a[144:147], a[176:179], v[52:55]
    s_waitcnt lgkmcnt(3)
    v_cvt_pk_bf16_f32 v114, v172, v173
    v_add_f32 v174, v154, v158
    v_mfma_f32_16x16x32_bf16 v[52:55], v[244:247], a[180:183], v[52:55]
    ds_write_b128 v4, v[108:111] offset:0
    v_mfma_f32_16x16x32_bf16 v[52:55], a[160:163], a[184:187], v[52:55]
    s_waitcnt lgkmcnt(3)
    v_add_f32 v175, v155, v159
    v_cvt_pk_bf16_f32 v115, v174, v175
    v_mfma_f32_16x16x32_bf16 v[56:59], v[240:243], a[176:179], v[56:59]
    v_sub_f32 v176, v128, v168
    v_sub_f32 v177, v129, v169
    v_mfma_f32_16x16x32_bf16 v[56:59], a[152:155], a[180:183], v[56:59]
    ds_write_b128 v14, v[32:35] offset:2048
    v_mfma_f32_16x16x32_bf16 v[56:59], a[164:167], a[184:187], v[56:59]
    v_cvt_pk_bf16_f32 v116, v176, v177
    v_sub_f32 v178, v130, v170
    v_mfma_f32_16x16x32_bf16 v[60:63], a[0:3], a[188:191], v[24:27]
    buffer_store_dwordx4 a[212:215], v22, s[24:27], s38 offen offset:1024 sc0 sc1
    v_mfma_f32_16x16x32_bf16 v[60:63], a[12:15], a[192:195], v[60:63]
    ds_read_b128 a[168:171], v12 offset:38464
    v_sub_f32 v179, v131, v171
    v_mfma_f32_16x16x32_bf16 v[60:63], a[24:27], a[196:199], v[60:63]
    ds_read_b128 a[172:175], v12 offset:38656
    v_cvt_pk_bf16_f32 v117, v178, v179
    v_mfma_f32_16x16x32_bf16 v[64:67], a[4:7], a[188:191], v[28:31]
    ds_read_b128 a[176:179], v12 offset:38848
    v_sub_f32 v180, v152, v156
    v_mfma_f32_16x16x32_bf16 v[64:67], a[16:19], a[192:195], v[64:67]
    ds_read_b128 a[180:183], v13 offset:39040
    v_sub_f32 v181, v153, v157
    v_mfma_f32_16x16x32_bf16 v[64:67], a[28:31], a[196:199], v[64:67]
    ds_read_b128 a[184:187], v13 offset:39232
    v_cvt_pk_bf16_f32 v118, v180, v181
    v_mfma_f32_16x16x32_bf16 v[68:71], a[8:11], a[188:191], v[32:35]
    ds_write_b128 v4, v[112:115] offset:9600
    v_mfma_f32_16x16x32_bf16 v[68:71], a[20:23], a[192:195], v[68:71]
    v_sub_f32 v182, v154, v158
    v_sub_f32 v183, v155, v159
    v_mfma_f32_16x16x32_bf16 v[68:71], a[32:35], a[196:199], v[68:71]
    v_cvt_pk_bf16_f32 v119, v182, v183
    v_mfma_f32_16x16x32_bf16 v[72:75], a[0:3], a[192:195], v[36:39]
    s_waitcnt vmcnt(7)
    v_lshlrev_b32 v160, 16, v136
    v_and_b32 v161, s16, v136
    v_mfma_f32_16x16x32_bf16 v[72:75], a[12:15], a[196:199], v[72:75]
    buffer_store_dwordx4 a[216:219], v22, s[24:27], s38 offen offset:2048 sc0 sc1
    v_mfma_f32_16x16x32_bf16 v[72:75], a[24:27], a[200:203], v[72:75]
    ds_write_b128 v14, v[36:39] offset:3072
    v_mfma_f32_16x16x32_bf16 v[76:79], a[4:7], a[192:195], v[40:43]
    v_lshlrev_b32 v162, 16, v137
    v_and_b32 v163, s16, v137
    v_mfma_f32_16x16x32_bf16 v[76:79], a[16:19], a[196:199], v[76:79]
    v_lshlrev_b32 v172, 16, v138
    v_and_b32 v173, s16, v138
    v_mfma_f32_16x16x32_bf16 v[76:79], a[28:31], a[200:203], v[76:79]
    ds_write_b128 v4, v[116:119] offset:19200
    v_mfma_f32_16x16x32_bf16 v[80:83], a[8:11], a[192:195], v[44:47]
    v_lshlrev_b32 v174, 16, v139
    v_and_b32 v175, s16, v139
    v_mfma_f32_16x16x32_bf16 v[80:83], a[20:23], a[196:199], v[80:83]
    buffer_load_dwordx4 v[136:139], v2, s[12:15], s18 offen
    v_sub_f32 v184, v184, v160
    v_mfma_f32_16x16x32_bf16 v[80:83], a[32:35], a[200:203], v[80:83]
    ds_write_b128 v14, v[40:43] offset:4096
    v_mfma_f32_16x16x32_bf16 v[84:87], a[0:3], a[196:199], v[48:51]
    v_sub_f32 v185, v185, v161
    v_cvt_pk_bf16_f32 v120, v184, v185
    v_mfma_f32_16x16x32_bf16 v[84:87], a[12:15], a[200:203], v[84:87]
    v_sub_f32 v186, v186, v162
    v_sub_f32 v187, v187, v163
    v_mfma_f32_16x16x32_bf16 v[84:87], a[24:27], a[204:207], v[84:87]
    ds_write_b128 v14, v[44:47] offset:5120
    v_mfma_f32_16x16x32_bf16 v[88:91], a[4:7], a[196:199], v[52:55]
    v_cvt_pk_bf16_f32 v121, v186, v187
    v_sub_f32 v188, v188, v172
    v_mfma_f32_16x16x32_bf16 v[88:91], a[16:19], a[200:203], v[88:91]
    buffer_store_dwordx4 a[220:223], v22, s[24:27], s38 offen offset:3072 sc0 sc1
    v_mfma_f32_16x16x32_bf16 v[88:91], a[28:31], a[204:207], v[88:91]
L_stub2:
    s_cbranch_execz L_back
    ds_write_b128 v14, v[48:51] offset:6144
    v_mfma_f32_16x16x32_bf16 v[92:95], a[8:11], a[196:199], v[56:59]
    v_sub_f32 v189, v189, v173
    v_cvt_pk_bf16_f32 v122, v188, v189
    v_mfma_f32_16x16x32_bf16 v[92:95], a[20:23], a[200:203], v[92:95]
    v_sub_f32 v190, v190, v174
    v_sub_f32 v191, v191, v175
    v_mfma_f32_16x16x32_bf16 v[92:95], a[32:35], a[204:207], v[92:95]
    s_waitcnt lgkmcnt(6)
    v_cvt_pk_bf16_f32 v123, v190, v191
    v_add_f32 v176, v196, v160
    v_mfma_f32_16x16x32_bf16 v[60:63], a[36:39], a[168:171], v[60:63]
    ds_write_b128 v5, v[120:123] offset:0
    v_mfma_f32_16x16x32_bf16 v[60:63], a[48:51], a[172:175], v[60:63]
    v_add_f32 v177, v197, v161
    v_cvt_pk_bf16_f32 v108, v176, v177
    v_mfma_f32_16x16x32_bf16 v[60:63], a[60:63], a[176:179], v[60:63]
    v_add_f32 v178, v198, v162
    v_add_f32 v179, v199, v163
    v_mfma_f32_16x16x32_bf16 v[64:67], a[40:43], a[168:171], v[64:67]
    ds_read_b128 a[188:191], v12 offset:38528
    v_cvt_pk_bf16_f32 v109, v178, v179
    v_mfma_f32_16x16x32_bf16 v[64:67], a[52:55], a[172:175], v[64:67]
    ds_read_b128 a[192:195], v12 offset:38720
    v_add_f32 v180, v124, v172
    v_mfma_f32_16x16x32_bf16 v[64:67], a[64:67], a[176:179], v[64:67]
    ds_read_b128 a[196:199], v12 offset:38912
    v_add_f32 v181, v125, v173
    v_mfma_f32_16x16x32_bf16 v[68:71], a[44:47], a[168:171], v[68:71]
    ds_read_b128 a[200:203], v13 offset:39104
    v_cvt_pk_bf16_f32 v110, v180, v181
    v_mfma_f32_16x16x32_bf16 v[68:71], a[56:59], a[172:175], v[68:71]
    ds_read_b128 a[204:207], v13 offset:39296
    v_add_f32 v182, v126, v174
    v_mfma_f32_16x16x32_bf16 v[68:71], a[68:71], a[176:179], v[68:71]
    buffer_store_dwordx4 a[224:227], v23, s[24:27], s38 offen sc0 sc1
    v_mfma_f32_16x16x32_bf16 v[72:75], a[36:39], a[172:175], v[72:75]
    ds_write_b128 v14, v[52:55] offset:7168
    v_mfma_f32_16x16x32_bf16 v[72:75], a[48:51], a[176:179], v[72:75]
    s_add_u32 s38, s38, s98
    v_add_f32 v183, v127, v175
    v_cvt_pk_bf16_f32 v111, v182, v183
    v_mfma_f32_16x16x32_bf16 v[72:75], a[60:63], a[180:183], v[72:75]
    v_sub_f32 v184, v196, v160
    v_sub_f32 v185, v197, v161
    v_mfma_f32_16x16x32_bf16 v[76:79], a[40:43], a[172:175], v[76:79]
    ds_write_b128 v5, v[108:111] offset:9600
    v_mfma_f32_16x16x32_bf16 v[76:79], a[52:55], a[176:179], v[76:79]
    v_cvt_pk_bf16_f32 v112, v184, v185
    v_sub_f32 v186, v198, v162
    v_mfma_f32_16x16x32_bf16 v[76:79], a[64:67], a[180:183], v[76:79]
    v_sub_f32 v187, v199, v163
    v_cvt_pk_bf16_f32 v113, v186, v187
    v_mfma_f32_16x16x32_bf16 v[80:83], a[44:47], a[172:175], v[80:83]
    ds_write_b128 v14, v[56:59] offset:8192
    v_mfma_f32_16x16x32_bf16 v[80:83], a[56:59], a[176:179], v[80:83]
    v_sub_f32 v188, v124, v172
    v_sub_f32 v189, v125, v173
    v_mfma_f32_16x16x32_bf16 v[80:83], a[68:71], a[180:183], v[80:83]
    v_cvt_pk_bf16_f32 v114, v188, v189
    v_sub_f32 v190, v126, v174
    v_mfma_f32_16x16x32_bf16 v[84:87], a[36:39], a[176:179], v[84:87]
    v_sub_f32 v191, v127, v175
    v_cvt_pk_bf16_f32 v115, v190, v191
    v_mfma_f32_16x16x32_bf16 v[84:87], a[48:51], a[180:183], v[84:87]
    s_waitcnt vmcnt(10)
    v_lshlrev_b32 v176, 16, v140
    v_and_b32 v177, s16, v140
    v_mfma_f32_16x16x32_bf16 v[84:87], a[60:63], a[184:187], v[84:87]
    ds_write_b128 v5, v[112:115] offset:19200
    v_mfma_f32_16x16x32_bf16 v[88:91], a[40:43], a[176:179], v[88:91]
    v_lshlrev_b32 v178, 16, v141
    v_and_b32 v179, s16, v141
    v_mfma_f32_16x16x32_bf16 v[88:91], a[52:55], a[180:183], v[88:91]
    buffer_load_dwordx2 v[140:141], v3, s[12:15], s18 offen
    v_sub_f32 v192, v192, v176
    v_mfma_f32_16x16x32_bf16 v[88:91], a[64:67], a[184:187], v[88:91]
    s_add_u32 s18, s18, s98
    v_sub_f32 v193, v193, v177
    v_cvt_pk_bf16_f32 v116, v192, v193
    v_mfma_f32_16x16x32_bf16 v[92:95], a[44:47], a[176:179], v[92:95]
    v_sub_f32 v194, v194, v178
    v_sub_f32 v195, v195, v179
    v_mfma_f32_16x16x32_bf16 v[92:95], a[56:59], a[180:183], v[92:95]
    v_cvt_pk_bf16_f32 v117, v194, v195
    v_add_f32 v180, v164, v176
    v_mfma_f32_16x16x32_bf16 v[92:95], a[68:71], a[184:187], v[92:95]
    s_waitcnt lgkmcnt(4)
    v_add_f32 v181, v165, v177
    v_cvt_pk_bf16_f32 v120, v180, v181
    v_mfma_f32_16x16x32_bf16 v[60:63], a[72:75], a[188:191], v[60:63]
    ds_write_b64 v6, v[116:117] offset:0
    v_mfma_f32_16x16x32_bf16 v[60:63], a[84:87], a[192:195], v[60:63]
    v_add_f32 v182, v166, v178
    v_add_f32 v183, v167, v179
    v_mfma_f32_16x16x32_bf16 v[60:63], a[96:99], a[196:199], v[60:63]
    v_cvt_pk_bf16_f32 v121, v182, v183
    v_sub_f32 v184, v164, v176
    v_mfma_f32_16x16x32_bf16 v[64:67], a[76:79], a[188:191], v[64:67]
    ds_write_b64 v6, v[120:121] offset:9600
    v_sub_f32 v185, v165, v177
    v_cvt_pk_bf16_f32 v108, v184, v185
    v_mfma_f32_16x16x32_bf16 v[64:67], a[88:91], a[192:195], v[64:67]
    v_sub_f32 v186, v166, v178
    v_sub_f32 v187, v167, v179
    v_cvt_pk_bf16_f32 v109, v186, v187
    v_mfma_f32_16x16x32_bf16 v[64:67], a[100:103], a[196:199], v[64:67]
    s_waitcnt vmcnt(10)
    v_lshlrev_b32 v188, 16, v144
    v_and_b32 v189, s16, v144
    v_mfma_f32_16x16x32_bf16 v[68:71], a[80:83], a[188:191], v[68:71]
    ds_write_b64 v6, v[108:109] offset:19200
    v_mfma_f32_16x16x32_bf16 v[68:71], a[92:95], a[192:195], v[68:71]
    v_lshlrev_b32 v190, 16, v145
    v_and_b32 v191, s16, v145
    v_mfma_f32_16x16x32_bf16 v[68:71], a[104:107], a[196:199], v[68:71]
    v_lshlrev_b32 v192, 16, v146
    v_and_b32 v193, s16, v146
    v_mfma_f32_16x16x32_bf16 v[72:75], a[72:75], a[192:195], v[72:75]
    v_lshlrev_b32 v194, 16, v147
    v_and_b32 v195, s16, v147
    v_mfma_f32_16x16x32_bf16 v[72:75], a[84:87], a[196:199], v[72:75]
    buffer_load_dwordx4 v[144:147], v1, s[12:15], s19 offen
    v_sub_f32 v128, v188, v128
    v_mfma_f32_16x16x32_bf16 v[72:75], a[96:99], a[200:203], v[72:75]
    s_waitcnt lgkmcnt(0)
    s_barrier
    v_sub_f32 v129, v189, v129
    v_mfma_f32_16x16x32_bf16 v[76:79], a[76:79], a[192:195], v[76:79]
    ds_read_b128 v[96:99], v15 offset:0
    v_cvt_pk_bf16_f32 v112, v128, v129
    v_mfma_f32_16x16x32_bf16 v[76:79], a[88:91], a[196:199], v[76:79]
    ds_read_b128 a[168:171], v10 offset:0
    v_sub_f32 v130, v190, v130
    v_mfma_f32_16x16x32_bf16 v[76:79], a[100:103], a[200:203], v[76:79]
    ds_read_b128 a[172:175], v10 offset:192
    v_sub_f32 v131, v191, v131
    v_mfma_f32_16x16x32_bf16 v[80:83], a[80:83], a[192:195], v[80:83]
    ds_read_b128 a[176:179], v10 offset:384
    v_cvt_pk_bf16_f32 v113, v130, v131
    v_mfma_f32_16x16x32_bf16 v[80:83], a[92:95], a[196:199], v[80:83]
    ds_read_b128 a[180:183], v11 offset:576
    v_sub_f32 v152, v192, v152
    v_mfma_f32_16x16x32_bf16 v[80:83], a[104:107], a[200:203], v[80:83]
    ds_read_b128 a[184:187], v11 offset:768
    v_sub_f32 v153, v193, v153
    v_mfma_f32_16x16x32_bf16 v[84:87], a[72:75], a[196:199], v[84:87]
    ds_read_b128 v[100:103], v15 offset:1024
    v_cvt_pk_bf16_f32 v114, v152, v153
    v_mfma_f32_16x16x32_bf16 v[84:87], a[84:87], a[200:203], v[84:87]
    ds_read_b128 v[104:107], v15 offset:2048
    v_sub_f32 v154, v194, v154
    v_mfma_f32_16x16x32_bf16 v[84:87], a[96:99], a[204:207], v[84:87]
    v_sub_f32 v155, v195, v155
    v_cvt_pk_bf16_f32 v115, v154, v155
    v_mfma_f32_16x16x32_bf16 v[88:91], a[76:79], a[196:199], v[88:91]
    s_waitcnt vmcnt(10)
    v_lshlrev_b32 v180, 16, v148
    v_and_b32 v181, s16, v148
    v_mfma_f32_16x16x32_bf16 v[88:91], a[88:91], a[200:203], v[88:91]
    s_waitcnt lgkmcnt(7)
    v_fma_f32 v60, v96, s17, v60
    v_fma_f32 v61, v97, s17, v61
    v_mfma_f32_16x16x32_bf16 v[88:91], a[100:103], a[204:207], v[88:91]
    ds_write_b128 v4, v[112:115] offset:28800
    v_mfma_f32_16x16x32_bf16 v[92:95], a[80:83], a[196:199], v[92:95]
    v_fma_f32 v62, v98, s17, v62
    v_fma_f32 v63, v99, s17, v63
    v_mfma_f32_16x16x32_bf16 v[92:95], a[92:95], a[200:203], v[92:95]
    v_cvt_pk_bf16_f32 v60, v60, v61
    v_cvt_pk_bf16_f32 v61, v62, v63
    v_mfma_f32_16x16x32_bf16 v[92:95], a[104:107], a[204:207], v[92:95]
    s_waitcnt lgkmcnt(3)
    v_lshlrev_b32 v182, 16, v149
    v_and_b32 v183, s16, v149
    v_mfma_f32_16x16x32_bf16 v[24:27], v[200:203], a[168:171], 0
    ds_read_b128 v[96:99], v15 offset:3072
    v_lshlrev_b32 v184, 16, v150
    v_mfma_f32_16x16x32_bf16 v[24:27], a[112:115], a[172:175], v[24:27]
    s_waitcnt lgkmcnt(3)
    v_fma_f32 v64, v100, s17, v64
    v_fma_f32 v65, v101, s17, v65
    v_mfma_f32_16x16x32_bf16 v[24:27], v[212:215], a[176:179], v[24:27]
    ds_read_b128 a[188:191], v10 offset:64
    v_fma_f32 v66, v102, s17, v66
    v_mfma_f32_16x16x32_bf16 v[28:31], a[108:111], a[168:171], 0
    ds_read_b128 a[192:195], v10 offset:256
    v_fma_f32 v67, v103, s17, v67
    v_mfma_f32_16x16x32_bf16 v[28:31], v[208:211], a[172:175], v[28:31]
    ds_read_b128 v[100:103], v15 offset:4096
    v_cvt_pk_bf16_f32 v64, v64, v65
    v_mfma_f32_16x16x32_bf16 v[28:31], a[120:123], a[176:179], v[28:31]
    ds_read_b128 a[196:199], v10 offset:448
    v_cvt_pk_bf16_f32 v65, v66, v67
    v_mfma_f32_16x16x32_bf16 v[32:35], v[204:207], a[168:171], 0
    s_waitcnt lgkmcnt(6)
    v_fma_f32 v68, v104, s17, v68
    v_fma_f32 v69, v105, s17, v69
    v_mfma_f32_16x16x32_bf16 v[32:35], a[116:119], a[172:175], v[32:35]
    ds_write2_b64 v16, v[60:61], v[64:65] offset0:0 offset1:4
    v_mfma_f32_16x16x32_bf16 v[32:35], v[216:219], a[176:179], v[32:35]
    v_fma_f32 v70, v106, s17, v70
    v_fma_f32 v71, v107, s17, v71
    v_mfma_f32_16x16x32_bf16 v[36:39], v[200:203], a[172:175], 0
    v_cvt_pk_bf16_f32 v68, v68, v69
    v_cvt_pk_bf16_f32 v69, v70, v71
    v_mfma_f32_16x16x32_bf16 v[36:39], a[112:115], a[176:179], v[36:39]
    s_waitcnt lgkmcnt(5)
    v_and_b32 v185, s16, v150
    v_fma_f32 v72, v96, s17, v72
    v_mfma_f32_16x16x32_bf16 v[36:39], v[212:215], a[180:183], v[36:39]
    ds_read_b128 v[104:107], v15 offset:5120
    v_lshlrev_b32 v186, 16, v151
    v_mfma_f32_16x16x32_bf16 v[40:43], a[108:111], a[172:175], 0
    ds_read_b128 a[200:203], v11 offset:640
    v_fma_f32 v73, v97, s17, v73
    v_mfma_f32_16x16x32_bf16 v[40:43], v[208:211], a[176:179], v[40:43]
    ds_read_b128 a[204:207], v11 offset:832
    v_and_b32 v187, s16, v151
    v_mfma_f32_16x16x32_bf16 v[40:43], a[120:123], a[180:183], v[40:43]
    buffer_load_dwordx4 v[148:151], v2, s[12:15], s19 offen
    v_fma_f32 v74, v98, s17, v74
    v_mfma_f32_16x16x32_bf16 v[44:47], v[204:207], a[172:175], 0
    v_fma_f32 v75, v99, s17, v75
    v_sub_f32 v196, v180, v196
    v_mfma_f32_16x16x32_bf16 v[44:47], a[116:119], a[176:179], v[44:47]
    ds_read_b128 v[96:99], v15 offset:6144
    v_cvt_pk_bf16_f32 v72, v72, v73
    v_mfma_f32_16x16x32_bf16 v[44:47], v[216:219], a[180:183], v[44:47]
    v_sub_f32 v197, v181, v197
    v_cvt_pk_bf16_f32 v73, v74, v75
    v_mfma_f32_16x16x32_bf16 v[48:51], v[200:203], a[176:179], 0
    s_waitcnt lgkmcnt(6)
    v_cvt_pk_bf16_f32 v116, v196, v197
    v_fma_f32 v76, v100, s17, v76
    v_mfma_f32_16x16x32_bf16 v[48:51], a[112:115], a[180:183], v[48:51]
    ds_write2_b64 v16, v[68:69], v[72:73] offset0:8 offset1:24
    v_mfma_f32_16x16x32_bf16 v[48:51], v[212:215], a[184:187], v[48:51]
    v_fma_f32 v77, v101, s17, v77
    v_sub_f32 v198, v182, v198
    v_mfma_f32_16x16x32_bf16 v[52:55], a[108:111], a[176:179], 0
    v_fma_f32 v78, v102, s17, v78
    v_sub_f32 v199, v183, v199
    v_mfma_f32_16x16x32_bf16 v[52:55], v[208:211], a[180:183], v[52:55]
    v_fma_f32 v79, v103, s17, v79
    v_cvt_pk_bf16_f32 v76, v76, v77
    v_mfma_f32_16x16x32_bf16 v[52:55], a[120:123], a[184:187], v[52:55]
    ds_read_b128 v[100:103], v15 offset:7168
    v_cvt_pk_bf16_f32 v117, v198, v199
    v_mfma_f32_16x16x32_bf16 v[56:59], v[204:207], a[176:179], 0
    v_cvt_pk_bf16_f32 v77, v78, v79
    v_sub_f32 v124, v184, v124
    v_mfma_f32_16x16x32_bf16 v[56:59], a[116:119], a[180:183], v[56:59]
    s_waitcnt lgkmcnt(5)
    v_fma_f32 v80, v104, s17, v80
    v_sub_f32 v125, v185, v125
    v_mfma_f32_16x16x32_bf16 v[56:59], v[216:219], a[184:187], v[56:59]
    s_waitcnt lgkmcnt(3)
    v_fma_f32 v81, v105, s17, v81
    v_fma_f32 v82, v106, s17, v82
    v_mfma_f32_16x16x32_bf16 v[24:27], a[124:127], a[188:191], v[24:27]
    v_cvt_pk_bf16_f32 v118, v124, v125
    v_fma_f32 v83, v107, s17, v83
    v_mfma_f32_16x16x32_bf16 v[24:27], v[224:227], a[192:195], v[24:27]
    ds_read_b128 v[104:107], v15 offset:8192
    v_sub_f32 v126, v186, v126
    v_mfma_f32_16x16x32_bf16 v[24:27], a[136:139], a[196:199], v[24:27]
    ds_read_b128 a[168:171], v10 offset:128
    v_cvt_pk_bf16_f32 v80, v80, v81
    v_mfma_f32_16x16x32_bf16 v[28:31], v[220:223], a[188:191], v[28:31]
    ds_read_b128 a[172:175], v10 offset:320
    v_cvt_pk_bf16_f32 v81, v82, v83
    v_mfma_f32_16x16x32_bf16 v[28:31], a[132:135], a[192:195], v[28:31]
    s_waitcnt lgkmcnt(5)
    v_sub_f32 v127, v187, v127
    v_fma_f32 v84, v96, s17, v84
    v_mfma_f32_16x16x32_bf16 v[28:31], v[232:235], a[196:199], v[28:31]
    ds_write2_b64 v16, v[76:77], v[80:81] offset0:28 offset1:32
    v_mfma_f32_16x16x32_bf16 v[32:35], a[128:131], a[188:191], v[32:35]
    v_cvt_pk_bf16_f32 v119, v126, v127
    v_fma_f32 v85, v97, s17, v85
    v_mfma_f32_16x16x32_bf16 v[32:35], v[228:231], a[192:195], v[32:35]
    s_waitcnt vmcnt(10)
    v_fma_f32 v86, v98, s17, v86
    v_fma_f32 v87, v99, s17, v87
    v_mfma_f32_16x16x32_bf16 v[32:35], a[140:143], a[196:199], v[32:35]
    ds_write_b128 v5, v[116:119] offset:28800
    v_mfma_f32_16x16x32_bf16 v[36:39], a[124:127], a[192:195], v[36:39]
    v_lshlrev_b32 v128, 16, v142
    v_cvt_pk_bf16_f32 v84, v84, v85
    v_mfma_f32_16x16x32_bf16 v[36:39], v[224:227], a[196:199], v[36:39]
    v_and_b32 v129, s16, v142
    v_cvt_pk_bf16_f32 v85, v86, v87
    v_mfma_f32_16x16x32_bf16 v[36:39], a[136:139], a[200:203], v[36:39]
    s_waitcnt lgkmcnt(5)
    v_lshlrev_b32 v130, 16, v143
    v_fma_f32 v88, v100, s17, v88
    v_mfma_f32_16x16x32_bf16 v[40:43], v[220:223], a[192:195], v[40:43]
    ds_read_b128 a[176:179], v10 offset:512
    v_fma_f32 v89, v101, s17, v89
    v_mfma_f32_16x16x32_bf16 v[40:43], a[132:135], a[196:199], v[40:43]
    ds_read_b128 a[180:183], v11 offset:704
    v_and_b32 v131, s16, v143
    v_mfma_f32_16x16x32_bf16 v[40:43], v[232:235], a[200:203], v[40:43]
    ds_read_b128 a[184:187], v11 offset:896
    v_fma_f32 v90, v102, s17, v90
    v_mfma_f32_16x16x32_bf16 v[44:47], a[128:131], a[192:195], v[44:47]
    buffer_load_dwordx2 v[142:143], v3, s[12:15], s19 offen
    v_sub_f32 v164, v128, v164
    v_mfma_f32_16x16x32_bf16 v[44:47], v[228:231], a[196:199], v[44:47]
    s_add_u32 s19, s19, s98
    v_fma_f32 v91, v103, s17, v91
    v_cvt_pk_bf16_f32 v88, v88, v89
    v_mfma_f32_16x16x32_bf16 v[44:47], a[140:143], a[200:203], v[44:47]
    v_sub_f32 v165, v129, v165
    v_cvt_pk_bf16_f32 v89, v90, v91
    v_mfma_f32_16x16x32_bf16 v[48:51], a[124:127], a[196:199], v[48:51]
    s_waitcnt lgkmcnt(7)
    v_cvt_pk_bf16_f32 v120, v164, v165
    v_fma_f32 v92, v104, s17, v92
    v_mfma_f32_16x16x32_bf16 v[48:51], v[224:227], a[200:203], v[48:51]
    ds_write2_b64 v16, v[84:85], v[88:89] offset0:48 offset1:52
    v_mfma_f32_16x16x32_bf16 v[48:51], a[136:139], a[204:207], v[48:51]
    v_sub_f32 v166, v130, v166
    v_fma_f32 v93, v105, s17, v93
    v_mfma_f32_16x16x32_bf16 v[52:55], v[220:223], a[196:199], v[52:55]
    v_fma_f32 v94, v106, s17, v94
    v_sub_f32 v167, v131, v167
    v_mfma_f32_16x16x32_bf16 v[52:55], a[132:135], a[200:203], v[52:55]
    v_fma_f32 v95, v107, s17, v95
    v_cvt_pk_bf16_f32 v121, v166, v167
    v_mfma_f32_16x16x32_bf16 v[52:55], v[232:235], a[204:207], v[52:55]
    ds_write_b64 v6, v[120:121] offset:28800
    v_cvt_pk_bf16_f32 v92, v92, v93
    v_cvt_pk_bf16_f32 v93, v94, v95
    v_mfma_f32_16x16x32_bf16 v[56:59], a[128:131], a[196:199], v[56:59]
    s_waitcnt vmcnt(10)
    v_lshlrev_b32 v152, 16, v132
    v_and_b32 v153, s16, v132
    v_mfma_f32_16x16x32_bf16 v[56:59], v[228:231], a[200:203], v[56:59]
    v_lshlrev_b32 v154, 16, v133
    v_and_b32 v155, s16, v133
    v_mfma_f32_16x16x32_bf16 v[56:59], a[140:143], a[204:207], v[56:59]
    s_waitcnt lgkmcnt(2)
    ds_write_b64 v16, v[92:93] offset:448
    v_mfma_f32_16x16x32_bf16 v[24:27], v[236:239], a[168:171], v[24:27]
    v_lshlrev_b32 v196, 16, v134
    v_and_b32 v197, s16, v134
    v_mfma_f32_16x16x32_bf16 v[24:27], a[148:151], a[172:175], v[24:27]
    v_lshlrev_b32 v198, 16, v135
    v_and_b32 v199, s16, v135
    v_mfma_f32_16x16x32_bf16 v[24:27], a[156:159], a[176:179], v[24:27]
    buffer_load_dwordx4 v[132:135], v1, s[12:15], s18 offen
    v_sub_f32 v168, v168, v152
    v_mfma_f32_16x16x32_bf16 v[28:31], a[144:147], a[168:171], v[28:31]
    s_waitcnt lgkmcnt(0)
    s_barrier
    v_sub_f32 v169, v169, v153
    v_mfma_f32_16x16x32_bf16 v[28:31], v[244:247], a[172:175], v[28:31]
    ds_read_b128 a[208:211], v17
    v_cvt_pk_bf16_f32 v108, v168, v169
    v_mfma_f32_16x16x32_bf16 v[28:31], a[160:163], a[176:179], v[28:31]
    ds_read_b128 a[212:215], v18
    v_sub_f32 v170, v170, v154
    v_mfma_f32_16x16x32_bf16 v[32:35], v[240:243], a[168:171], v[32:35]
    ds_read_b128 a[188:191], v12 offset:0
    v_sub_f32 v171, v171, v155
    v_mfma_f32_16x16x32_bf16 v[32:35], a[152:155], a[172:175], v[32:35]
    ds_read_b128 a[192:195], v12 offset:192
    v_cvt_pk_bf16_f32 v109, v170, v171
    v_mfma_f32_16x16x32_bf16 v[32:35], a[164:167], a[176:179], v[32:35]
    ds_read_b128 a[216:219], v19
    v_sub_f32 v156, v156, v196
    v_mfma_f32_16x16x32_bf16 v[36:39], v[236:239], a[172:175], v[36:39]
    ds_read_b128 a[196:199], v12 offset:384
    v_sub_f32 v157, v157, v197
    v_mfma_f32_16x16x32_bf16 v[36:39], a[148:151], a[176:179], v[36:39]
    ds_read_b128 a[200:203], v13 offset:576
    v_cvt_pk_bf16_f32 v110, v156, v157
    v_mfma_f32_16x16x32_bf16 v[36:39], a[156:159], a[180:183], v[36:39]
    ds_read_b128 a[204:207], v13 offset:768
    v_sub_f32 v158, v158, v198
    v_mfma_f32_16x16x32_bf16 v[40:43], a[144:147], a[172:175], v[40:43]
    ds_read_b128 a[220:223], v20
    v_sub_f32 v159, v159, v199
    v_mfma_f32_16x16x32_bf16 v[40:43], v[244:247], a[176:179], v[40:43]
    ds_read_b128 a[224:227], v21
    v_cvt_pk_bf16_f32 v111, v158, v159
    v_mfma_f32_16x16x32_bf16 v[40:43], a[160:163], a[180:183], v[40:43]
    s_waitcnt lgkmcnt(9)
    v_add_f32 v124, v188, v152
    v_add_f32 v125, v189, v153
    v_mfma_f32_16x16x32_bf16 v[44:47], v[240:243], a[172:175], v[44:47]
    s_waitcnt lgkmcnt(8)
    v_cvt_pk_bf16_f32 v112, v124, v125
    v_add_f32 v126, v190, v154
    v_mfma_f32_16x16x32_bf16 v[44:47], a[152:155], a[176:179], v[44:47]
    ds_write_b128 v14, v[24:27] offset:0
    v_mfma_f32_16x16x32_bf16 v[44:47], a[164:167], a[180:183], v[44:47]
    s_waitcnt lgkmcnt(6)
    v_add_f32 v127, v191, v155
    v_cvt_pk_bf16_f32 v113, v126, v127
    v_mfma_f32_16x16x32_bf16 v[48:51], v[236:239], a[176:179], v[48:51]
    buffer_store_dwordx4 a[208:211], v22, s[24:27], s38 offen offset:0 sc0 sc1
    v_mfma_f32_16x16x32_bf16 v[48:51], a[148:151], a[180:183], v[48:51]
    ds_write_b128 v14, v[28:31] offset:1024
    v_mfma_f32_16x16x32_bf16 v[48:51], a[156:159], a[184:187], v[48:51]
    v_add_f32 v164, v192, v196
    v_add_f32 v165, v193, v197
    v_mfma_f32_16x16x32_bf16 v[52:55], a[144:147], a[176:179], v[52:55]
    s_waitcnt lgkmcnt(3)
    v_cvt_pk_bf16_f32 v114, v164, v165
    v_add_f32 v166, v194, v198
    v_mfma_f32_16x16x32_bf16 v[52:55], v[244:247], a[180:183], v[52:55]
    ds_write_b128 v7, v[108:111] offset:0
    v_mfma_f32_16x16x32_bf16 v[52:55], a[160:163], a[184:187], v[52:55]
    s_waitcnt lgkmcnt(3)
    v_add_f32 v167, v195, v199
    v_cvt_pk_bf16_f32 v115, v166, v167
    v_mfma_f32_16x16x32_bf16 v[56:59], v[240:243], a[176:179], v[56:59]
    v_sub_f32 v168, v188, v152
    v_sub_f32 v169, v189, v153
    v_mfma_f32_16x16x32_bf16 v[56:59], a[152:155], a[180:183], v[56:59]
    ds_write_b128 v14, v[32:35] offset:2048
    v_mfma_f32_16x16x32_bf16 v[56:59], a[164:167], a[184:187], v[56:59]
    v_cvt_pk_bf16_f32 v116, v168, v169
    v_sub_f32 v170, v190, v154
    v_mfma_f32_16x16x32_bf16 v[60:63], a[0:3], a[188:191], v[24:27]
    buffer_store_dwordx4 a[212:215], v22, s[24:27], s38 offen offset:1024 sc0 sc1
    v_mfma_f32_16x16x32_bf16 v[60:63], a[12:15], a[192:195], v[60:63]
    ds_read_b128 a[168:171], v12 offset:64
    v_sub_f32 v171, v191, v155
    v_mfma_f32_16x16x32_bf16 v[60:63], a[24:27], a[196:199], v[60:63]
    ds_read_b128 a[172:175], v12 offset:256
    v_cvt_pk_bf16_f32 v117, v170, v171
    v_mfma_f32_16x16x32_bf16 v[64:67], a[4:7], a[188:191], v[28:31]
    ds_read_b128 a[176:179], v12 offset:448
    v_sub_f32 v156, v192, v196
    v_mfma_f32_16x16x32_bf16 v[64:67], a[16:19], a[192:195], v[64:67]
    ds_read_b128 a[180:183], v13 offset:640
    v_sub_f32 v157, v193, v197
    v_mfma_f32_16x16x32_bf16 v[64:67], a[28:31], a[196:199], v[64:67]
    ds_read_b128 a[184:187], v13 offset:832
    v_cvt_pk_bf16_f32 v118, v156, v157
    v_mfma_f32_16x16x32_bf16 v[68:71], a[8:11], a[188:191], v[32:35]
    ds_write_b128 v7, v[112:115] offset:9600
    v_mfma_f32_16x16x32_bf16 v[68:71], a[20:23], a[192:195], v[68:71]
    v_sub_f32 v158, v194, v198
    v_sub_f32 v159, v195, v199
    v_mfma_f32_16x16x32_bf16 v[68:71], a[32:35], a[196:199], v[68:71]
    v_cvt_pk_bf16_f32 v119, v158, v159
    v_mfma_f32_16x16x32_bf16 v[72:75], a[0:3], a[192:195], v[36:39]
    s_waitcnt vmcnt(9)
    v_lshlrev_b32 v124, 16, v136
    v_and_b32 v125, s16, v136
    v_mfma_f32_16x16x32_bf16 v[72:75], a[12:15], a[196:199], v[72:75]
    buffer_store_dwordx4 a[216:219], v22, s[24:27], s38 offen offset:2048 sc0 sc1
    v_mfma_f32_16x16x32_bf16 v[72:75], a[24:27], a[200:203], v[72:75]
    ds_write_b128 v14, v[36:39] offset:3072
    v_mfma_f32_16x16x32_bf16 v[76:79], a[4:7], a[192:195], v[40:43]
    v_lshlrev_b32 v126, 16, v137
    v_and_b32 v127, s16, v137
    v_mfma_f32_16x16x32_bf16 v[76:79], a[16:19], a[196:199], v[76:79]
    v_lshlrev_b32 v164, 16, v138
    v_and_b32 v165, s16, v138
    v_mfma_f32_16x16x32_bf16 v[76:79], a[28:31], a[200:203], v[76:79]
    ds_write_b128 v7, v[116:119] offset:19200
    v_mfma_f32_16x16x32_bf16 v[80:83], a[8:11], a[192:195], v[44:47]
    v_lshlrev_b32 v166, 16, v139
    v_and_b32 v167, s16, v139
    v_mfma_f32_16x16x32_bf16 v[80:83], a[20:23], a[196:199], v[80:83]
    buffer_load_dwordx4 v[136:139], v2, s[12:15], s18 offen
    v_sub_f32 v160, v160, v124
    v_mfma_f32_16x16x32_bf16 v[80:83], a[32:35], a[200:203], v[80:83]
    ds_write_b128 v14, v[40:43] offset:4096
    v_mfma_f32_16x16x32_bf16 v[84:87], a[0:3], a[196:199], v[48:51]
    v_sub_f32 v161, v161, v125
    v_cvt_pk_bf16_f32 v120, v160, v161
    v_mfma_f32_16x16x32_bf16 v[84:87], a[12:15], a[200:203], v[84:87]
    v_sub_f32 v162, v162, v126
    v_sub_f32 v163, v163, v127
    v_mfma_f32_16x16x32_bf16 v[84:87], a[24:27], a[204:207], v[84:87]
    ds_write_b128 v14, v[44:47] offset:5120
    v_mfma_f32_16x16x32_bf16 v[88:91], a[4:7], a[196:199], v[52:55]
    v_cvt_pk_bf16_f32 v121, v162, v163
    v_sub_f32 v172, v172, v164
    v_mfma_f32_16x16x32_bf16 v[88:91], a[16:19], a[200:203], v[88:91]
    buffer_store_dwordx4 a[220:223], v22, s[24:27], s38 offen offset:3072 sc0 sc1
    v_mfma_f32_16x16x32_bf16 v[88:91], a[28:31], a[204:207], v[88:91]
    ds_write_b128 v14, v[48:51] offset:6144
    v_mfma_f32_16x16x32_bf16 v[92:95], a[8:11], a[196:199], v[56:59]
    v_sub_f32 v173, v173, v165
    v_cvt_pk_bf16_f32 v122, v172, v173
    v_mfma_f32_16x16x32_bf16 v[92:95], a[20:23], a[200:203], v[92:95]
    v_sub_f32 v174, v174, v166
    v_sub_f32 v175, v175, v167
    v_mfma_f32_16x16x32_bf16 v[92:95], a[32:35], a[204:207], v[92:95]
    s_waitcnt lgkmcnt(6)
    v_cvt_pk_bf16_f32 v123, v174, v175
    v_add_f32 v168, v180, v124
    v_mfma_f32_16x16x32_bf16 v[60:63], a[36:39], a[168:171], v[60:63]
    ds_write_b128 v8, v[120:123] offset:0
    v_mfma_f32_16x16x32_bf16 v[60:63], a[48:51], a[172:175], v[60:63]
    v_add_f32 v169, v181, v125
    v_cvt_pk_bf16_f32 v108, v168, v169
    v_mfma_f32_16x16x32_bf16 v[60:63], a[60:63], a[176:179], v[60:63]
    v_add_f32 v170, v182, v126
    v_add_f32 v171, v183, v127
    v_mfma_f32_16x16x32_bf16 v[64:67], a[40:43], a[168:171], v[64:67]
    ds_read_b128 a[188:191], v12 offset:128
    v_cvt_pk_bf16_f32 v109, v170, v171
    v_mfma_f32_16x16x32_bf16 v[64:67], a[52:55], a[172:175], v[64:67]
    ds_read_b128 a[192:195], v12 offset:320
    v_add_f32 v156, v184, v164
    v_mfma_f32_16x16x32_bf16 v[64:67], a[64:67], a[176:179], v[64:67]
    ds_read_b128 a[196:199], v12 offset:512
    v_add_f32 v157, v185, v165
    v_mfma_f32_16x16x32_bf16 v[68:71], a[44:47], a[168:171], v[68:71]
    ds_read_b128 a[200:203], v13 offset:704
    v_cvt_pk_bf16_f32 v110, v156, v157
    v_mfma_f32_16x16x32_bf16 v[68:71], a[56:59], a[172:175], v[68:71]
    ds_read_b128 a[204:207], v13 offset:896
    v_add_f32 v158, v186, v166
    v_mfma_f32_16x16x32_bf16 v[68:71], a[68:71], a[176:179], v[68:71]
    buffer_store_dwordx4 a[224:227], v23, s[24:27], s38 offen sc0 sc1
    v_mfma_f32_16x16x32_bf16 v[72:75], a[36:39], a[172:175], v[72:75]
    ds_write_b128 v14, v[52:55] offset:7168
    v_mfma_f32_16x16x32_bf16 v[72:75], a[48:51], a[176:179], v[72:75]
    s_add_u32 s38, s38, s98
    v_add_f32 v159, v187, v167
    v_cvt_pk_bf16_f32 v111, v158, v159
    v_mfma_f32_16x16x32_bf16 v[72:75], a[60:63], a[180:183], v[72:75]
    v_sub_f32 v160, v180, v124
    v_sub_f32 v161, v181, v125
    v_mfma_f32_16x16x32_bf16 v[76:79], a[40:43], a[172:175], v[76:79]
    ds_write_b128 v8, v[108:111] offset:9600
    v_mfma_f32_16x16x32_bf16 v[76:79], a[52:55], a[176:179], v[76:79]
    v_cvt_pk_bf16_f32 v112, v160, v161
    v_sub_f32 v162, v182, v126
    v_mfma_f32_16x16x32_bf16 v[76:79], a[64:67], a[180:183], v[76:79]
    v_sub_f32 v163, v183, v127
    v_cvt_pk_bf16_f32 v113, v162, v163
    v_mfma_f32_16x16x32_bf16 v[80:83], a[44:47], a[172:175], v[80:83]
    ds_write_b128 v14, v[56:59] offset:8192
    v_mfma_f32_16x16x32_bf16 v[80:83], a[56:59], a[176:179], v[80:83]
    v_sub_f32 v172, v184, v164
    v_sub_f32 v173, v185, v165
    v_mfma_f32_16x16x32_bf16 v[80:83], a[68:71], a[180:183], v[80:83]
    v_cvt_pk_bf16_f32 v114, v172, v173
    v_sub_f32 v174, v186, v166
    v_mfma_f32_16x16x32_bf16 v[84:87], a[36:39], a[176:179], v[84:87]
    v_sub_f32 v175, v187, v167
    v_cvt_pk_bf16_f32 v115, v174, v175
    v_mfma_f32_16x16x32_bf16 v[84:87], a[48:51], a[180:183], v[84:87]
    s_waitcnt vmcnt(10)
    v_lshlrev_b32 v168, 16, v140
    v_and_b32 v169, s16, v140
    v_mfma_f32_16x16x32_bf16 v[84:87], a[60:63], a[184:187], v[84:87]
    ds_write_b128 v8, v[112:115] offset:19200
    v_mfma_f32_16x16x32_bf16 v[88:91], a[40:43], a[176:179], v[88:91]
    v_lshlrev_b32 v170, 16, v141
    v_and_b32 v171, s16, v141
    v_mfma_f32_16x16x32_bf16 v[88:91], a[52:55], a[180:183], v[88:91]
    buffer_load_dwordx2 v[140:141], v3, s[12:15], s18 offen
    v_sub_f32 v176, v176, v168
    v_mfma_f32_16x16x32_bf16 v[88:91], a[64:67], a[184:187], v[88:91]
    s_add_u32 s18, s18, s98
    v_sub_f32 v177, v177, v169
    v_cvt_pk_bf16_f32 v116, v176, v177
    v_mfma_f32_16x16x32_bf16 v[92:95], a[44:47], a[176:179], v[92:95]
    v_sub_f32 v178, v178, v170
    v_sub_f32 v179, v179, v171
    v_mfma_f32_16x16x32_bf16 v[92:95], a[56:59], a[180:183], v[92:95]
    v_cvt_pk_bf16_f32 v117, v178, v179
    v_add_f32 v156, v128, v168
    v_mfma_f32_16x16x32_bf16 v[92:95], a[68:71], a[184:187], v[92:95]
    s_waitcnt lgkmcnt(4)
    v_add_f32 v157, v129, v169
    v_cvt_pk_bf16_f32 v120, v156, v157
    v_mfma_f32_16x16x32_bf16 v[60:63], a[72:75], a[188:191], v[60:63]
    ds_write_b64 v9, v[116:117] offset:0
    v_mfma_f32_16x16x32_bf16 v[60:63], a[84:87], a[192:195], v[60:63]
    v_add_f32 v158, v130, v170
    v_add_f32 v159, v131, v171
    v_mfma_f32_16x16x32_bf16 v[60:63], a[96:99], a[196:199], v[60:63]
    v_cvt_pk_bf16_f32 v121, v158, v159
    v_sub_f32 v160, v128, v168
    v_mfma_f32_16x16x32_bf16 v[64:67], a[76:79], a[188:191], v[64:67]
    ds_write_b64 v9, v[120:121] offset:9600
    v_sub_f32 v161, v129, v169
    v_cvt_pk_bf16_f32 v108, v160, v161
    v_mfma_f32_16x16x32_bf16 v[64:67], a[88:91], a[192:195], v[64:67]
    v_sub_f32 v162, v130, v170
    v_sub_f32 v163, v131, v171
    v_cvt_pk_bf16_f32 v109, v162, v163
    v_mfma_f32_16x16x32_bf16 v[64:67], a[100:103], a[196:199], v[64:67]
    s_waitcnt vmcnt(10)
    v_lshlrev_b32 v172, 16, v144
    v_and_b32 v173, s16, v144
    v_mfma_f32_16x16x32_bf16 v[68:71], a[80:83], a[188:191], v[68:71]
    ds_write_b64 v9, v[108:109] offset:19200
    v_mfma_f32_16x16x32_bf16 v[68:71], a[92:95], a[192:195], v[68:71]
    v_lshlrev_b32 v174, 16, v145
    v_and_b32 v175, s16, v145
    v_mfma_f32_16x16x32_bf16 v[68:71], a[104:107], a[196:199], v[68:71]
    v_lshlrev_b32 v176, 16, v146
    v_and_b32 v177, s16, v146
    v_mfma_f32_16x16x32_bf16 v[72:75], a[72:75], a[192:195], v[72:75]
    v_lshlrev_b32 v178, 16, v147
    v_and_b32 v179, s16, v147
    v_mfma_f32_16x16x32_bf16 v[72:75], a[84:87], a[196:199], v[72:75]
    buffer_load_dwordx4 v[144:147], v1, s[12:15], s19 offen
    v_sub_f32 v188, v172, v188
    v_mfma_f32_16x16x32_bf16 v[72:75], a[96:99], a[200:203], v[72:75]
L_stub3:
    s_cbranch_execz L_back
    s_waitcnt lgkmcnt(0)
    s_barrier
    v_sub_f32 v189, v173, v189
    v_mfma_f32_16x16x32_bf16 v[76:79], a[76:79], a[192:195], v[76:79]
    ds_read_b128 v[96:99], v15 offset:0
    v_cvt_pk_bf16_f32 v112, v188, v189
    v_mfma_f32_16x16x32_bf16 v[76:79], a[88:91], a[196:199], v[76:79]
    ds_read_b128 a[168:171], v10 offset:38400
    v_sub_f32 v190, v174, v190
    v_mfma_f32_16x16x32_bf16 v[76:79], a[100:103], a[200:203], v[76:79]
    ds_read_b128 a[172:175], v10 offset:38592
    v_sub_f32 v191, v175, v191
    v_mfma_f32_16x16x32_bf16 v[80:83], a[80:83], a[192:195], v[80:83]
    ds_read_b128 a[176:179], v10 offset:38784
    v_cvt_pk_bf16_f32 v113, v190, v191
    v_mfma_f32_16x16x32_bf16 v[80:83], a[92:95], a[196:199], v[80:83]
    ds_read_b128 a[180:183], v11 offset:38976
    v_sub_f32 v192, v176, v192
    v_mfma_f32_16x16x32_bf16 v[80:83], a[104:107], a[200:203], v[80:83]
    ds_read_b128 a[184:187], v11 offset:39168
    v_sub_f32 v193, v177, v193
    v_mfma_f32_16x16x32_bf16 v[84:87], a[72:75], a[196:199], v[84:87]
    ds_read_b128 v[100:103], v15 offset:1024
    v_cvt_pk_bf16_f32 v114, v192, v193
    v_mfma_f32_16x16x32_bf16 v[84:87], a[84:87], a[200:203], v[84:87]
    ds_read_b128 v[104:107], v15 offset:2048
    v_sub_f32 v194, v178, v194
    v_mfma_f32_16x16x32_bf16 v[84:87], a[96:99], a[204:207], v[84:87]
    v_sub_f32 v195, v179, v195
    v_cvt_pk_bf16_f32 v115, v194, v195
    v_mfma_f32_16x16x32_bf16 v[88:91], a[76:79], a[196:199], v[88:91]
    s_waitcnt vmcnt(10)
    v_lshlrev_b32 v156, 16, v148
    v_and_b32 v157, s16, v148
    v_mfma_f32_16x16x32_bf16 v[88:91], a[88:91], a[200:203], v[88:91]
    s_waitcnt lgkmcnt(7)
    v_fma_f32 v60, v96, s17, v60
    v_fma_f32 v61, v97, s17, v61
    v_mfma_f32_16x16x32_bf16 v[88:91], a[100:103], a[204:207], v[88:91]
    ds_write_b128 v7, v[112:115] offset:28800
    v_mfma_f32_16x16x32_bf16 v[92:95], a[80:83], a[196:199], v[92:95]
    v_fma_f32 v62, v98, s17, v62
    v_fma_f32 v63, v99, s17, v63
    v_mfma_f32_16x16x32_bf16 v[92:95], a[92:95], a[200:203], v[92:95]
    v_cvt_pk_bf16_f32 v60, v60, v61
    v_cvt_pk_bf16_f32 v61, v62, v63
    v_mfma_f32_16x16x32_bf16 v[92:95], a[104:107], a[204:207], v[92:95]
    s_waitcnt lgkmcnt(3)
    v_lshlrev_b32 v158, 16, v149
    v_and_b32 v159, s16, v149
    v_mfma_f32_16x16x32_bf16 v[24:27], v[200:203], a[168:171], 0
    ds_read_b128 v[96:99], v15 offset:3072
    v_lshlrev_b32 v160, 16, v150
    v_mfma_f32_16x16x32_bf16 v[24:27], a[112:115], a[172:175], v[24:27]
    s_waitcnt lgkmcnt(3)
    v_fma_f32 v64, v100, s17, v64
    v_fma_f32 v65, v101, s17, v65
    v_mfma_f32_16x16x32_bf16 v[24:27], v[212:215], a[176:179], v[24:27]
    ds_read_b128 a[188:191], v10 offset:38464
    v_fma_f32 v66, v102, s17, v66
    v_mfma_f32_16x16x32_bf16 v[28:31], a[108:111], a[168:171], 0
    ds_read_b128 a[192:195], v10 offset:38656
    v_fma_f32 v67, v103, s17, v67
    v_mfma_f32_16x16x32_bf16 v[28:31], v[208:211], a[172:175], v[28:31]
    ds_read_b128 v[100:103], v15 offset:4096
    v_cvt_pk_bf16_f32 v64, v64, v65
    v_mfma_f32_16x16x32_bf16 v[28:31], a[120:123], a[176:179], v[28:31]
    ds_read_b128 a[196:199], v10 offset:38848
    v_cvt_pk_bf16_f32 v65, v66, v67
    v_mfma_f32_16x16x32_bf16 v[32:35], v[204:207], a[168:171], 0
    s_waitcnt lgkmcnt(6)
    v_fma_f32 v68, v104, s17, v68
    v_fma_f32 v69, v105, s17, v69
    v_mfma_f32_16x16x32_bf16 v[32:35], a[116:119], a[172:175], v[32:35]
    ds_write2_b64 v16, v[60:61], v[64:65] offset0:0 offset1:4
    v_mfma_f32_16x16x32_bf16 v[32:35], v[216:219], a[176:179], v[32:35]
    v_fma_f32 v70, v106, s17, v70
    v_fma_f32 v71, v107, s17, v71
    v_mfma_f32_16x16x32_bf16 v[36:39], v[200:203], a[172:175], 0
    v_cvt_pk_bf16_f32 v68, v68, v69
    v_cvt_pk_bf16_f32 v69, v70, v71
    v_mfma_f32_16x16x32_bf16 v[36:39], a[112:115], a[176:179], v[36:39]
    s_waitcnt lgkmcnt(5)
    v_and_b32 v161, s16, v150
    v_fma_f32 v72, v96, s17, v72
    v_mfma_f32_16x16x32_bf16 v[36:39], v[212:215], a[180:183], v[36:39]
    ds_read_b128 v[104:107], v15 offset:5120
    v_lshlrev_b32 v162, 16, v151
    v_mfma_f32_16x16x32_bf16 v[40:43], a[108:111], a[172:175], 0
    ds_read_b128 a[200:203], v11 offset:39040
    v_fma_f32 v73, v97, s17, v73
    v_mfma_f32_16x16x32_bf16 v[40:43], v[208:211], a[176:179], v[40:43]
    ds_read_b128 a[204:207], v11 offset:39232
    v_and_b32 v163, s16, v151
    v_mfma_f32_16x16x32_bf16 v[40:43], a[120:123], a[180:183], v[40:43]
    buffer_load_dwordx4 v[148:151], v2, s[12:15], s19 offen
    v_fma_f32 v74, v98, s17, v74
    v_mfma_f32_16x16x32_bf16 v[44:47], v[204:207], a[172:175], 0
    v_fma_f32 v75, v99, s17, v75
    v_sub_f32 v180, v156, v180
    v_mfma_f32_16x16x32_bf16 v[44:47], a[116:119], a[176:179], v[44:47]
    ds_read_b128 v[96:99], v15 offset:6144
    v_cvt_pk_bf16_f32 v72, v72, v73
    v_mfma_f32_16x16x32_bf16 v[44:47], v[216:219], a[180:183], v[44:47]
    v_sub_f32 v181, v157, v181
    v_cvt_pk_bf16_f32 v73, v74, v75
    v_mfma_f32_16x16x32_bf16 v[48:51], v[200:203], a[176:179], 0
    s_waitcnt lgkmcnt(6)
    v_cvt_pk_bf16_f32 v116, v180, v181
    v_fma_f32 v76, v100, s17, v76
    v_mfma_f32_16x16x32_bf16 v[48:51], a[112:115], a[180:183], v[48:51]
    ds_write2_b64 v16, v[68:69], v[72:73] offset0:8 offset1:24
    v_mfma_f32_16x16x32_bf16 v[48:51], v[212:215], a[184:187], v[48:51]
    v_fma_f32 v77, v101, s17, v77
    v_sub_f32 v182, v158, v182
    v_mfma_f32_16x16x32_bf16 v[52:55], a[108:111], a[176:179], 0
    v_fma_f32 v78, v102, s17, v78
    v_sub_f32 v183, v159, v183
    v_mfma_f32_16x16x32_bf16 v[52:55], v[208:211], a[180:183], v[52:55]
    v_fma_f32 v79, v103, s17, v79
    v_cvt_pk_bf16_f32 v76, v76, v77
    v_mfma_f32_16x16x32_bf16 v[52:55], a[120:123], a[184:187], v[52:55]
    ds_read_b128 v[100:103], v15 offset:7168
    v_cvt_pk_bf16_f32 v117, v182, v183
    v_mfma_f32_16x16x32_bf16 v[56:59], v[204:207], a[176:179], 0
    v_cvt_pk_bf16_f32 v77, v78, v79
    v_sub_f32 v184, v160, v184
    v_mfma_f32_16x16x32_bf16 v[56:59], a[116:119], a[180:183], v[56:59]
    s_waitcnt lgkmcnt(5)
    v_fma_f32 v80, v104, s17, v80
    v_sub_f32 v185, v161, v185
    v_mfma_f32_16x16x32_bf16 v[56:59], v[216:219], a[184:187], v[56:59]
    s_waitcnt lgkmcnt(3)
    v_fma_f32 v81, v105, s17, v81
    v_fma_f32 v82, v106, s17, v82
    v_mfma_f32_16x16x32_bf16 v[24:27], a[124:127], a[188:191], v[24:27]
    v_cvt_pk_bf16_f32 v118, v184, v185
    v_fma_f32 v83, v107, s17, v83
    v_mfma_f32_16x16x32_bf16 v[24:27], v[224:227], a[192:195], v[24:27]
    ds_read_b128 v[104:107], v15 offset:8192
    v_sub_f32 v186, v162, v186
    v_mfma_f32_16x16x32_bf16 v[24:27], a[136:139], a[196:199], v[24:27]
    ds_read_b128 a[168:171], v10 offset:38528
    v_cvt_pk_bf16_f32 v80, v80, v81
    v_mfma_f32_16x16x32_bf16 v[28:31], v[220:223], a[188:191], v[28:31]
    ds_read_b128 a[172:175], v10 offset:38720
    v_cvt_pk_bf16_f32 v81, v82, v83
    v_mfma_f32_16x16x32_bf16 v[28:31], a[132:135], a[192:195], v[28:31]
    s_waitcnt lgkmcnt(5)
    v_sub_f32 v187, v163, v187
    v_fma_f32 v84, v96, s17, v84
    v_mfma_f32_16x16x32_bf16 v[28:31], v[232:235], a[196:199], v[28:31]
    ds_write2_b64 v16, v[76:77], v[80:81] offset0:28 offset1:32
    v_mfma_f32_16x16x32_bf16 v[32:35], a[128:131], a[188:191], v[32:35]
    v_cvt_pk_bf16_f32 v119, v186, v187
    v_fma_f32 v85, v97, s17, v85
    v_mfma_f32_16x16x32_bf16 v[32:35], v[228:231], a[192:195], v[32:35]
    s_waitcnt vmcnt(10)
    v_fma_f32 v86, v98, s17, v86
    v_fma_f32 v87, v99, s17, v87
    v_mfma_f32_16x16x32_bf16 v[32:35], a[140:143], a[196:199], v[32:35]
    ds_write_b128 v8, v[116:119] offset:28800
    v_mfma_f32_16x16x32_bf16 v[36:39], a[124:127], a[192:195], v[36:39]
    v_lshlrev_b32 v188, 16, v142
    v_cvt_pk_bf16_f32 v84, v84, v85
    v_mfma_f32_16x16x32_bf16 v[36:39], v[224:227], a[196:199], v[36:39]
    v_and_b32 v189, s16, v142
    v_cvt_pk_bf16_f32 v85, v86, v87
    v_mfma_f32_16x16x32_bf16 v[36:39], a[136:139], a[200:203], v[36:39]
    s_waitcnt lgkmcnt(5)
    v_lshlrev_b32 v190, 16, v143
    v_fma_f32 v88, v100, s17, v88
    v_mfma_f32_16x16x32_bf16 v[40:43], v[220:223], a[192:195], v[40:43]
    ds_read_b128 a[176:179], v10 offset:38912
    v_fma_f32 v89, v101, s17, v89
    v_mfma_f32_16x16x32_bf16 v[40:43], a[132:135], a[196:199], v[40:43]
    ds_read_b128 a[180:183], v11 offset:39104
    v_and_b32 v191, s16, v143
    v_mfma_f32_16x16x32_bf16 v[40:43], v[232:235], a[200:203], v[40:43]
    ds_read_b128 a[184:187], v11 offset:39296
    v_fma_f32 v90, v102, s17, v90
    v_mfma_f32_16x16x32_bf16 v[44:47], a[128:131], a[192:195], v[44:47]
    buffer_load_dwordx2 v[142:143], v3, s[12:15], s19 offen
    v_sub_f32 v128, v188, v128
    v_mfma_f32_16x16x32_bf16 v[44:47], v[228:231], a[196:199], v[44:47]
    s_add_u32 s19, s19, s98
    v_fma_f32 v91, v103, s17, v91
    v_cvt_pk_bf16_f32 v88, v88, v89
    v_mfma_f32_16x16x32_bf16 v[44:47], a[140:143], a[200:203], v[44:47]
    v_sub_f32 v129, v189, v129
    v_cvt_pk_bf16_f32 v89, v90, v91
    v_mfma_f32_16x16x32_bf16 v[48:51], a[124:127], a[196:199], v[48:51]
    s_waitcnt lgkmcnt(7)
    v_cvt_pk_bf16_f32 v120, v128, v129
    v_fma_f32 v92, v104, s17, v92
    v_mfma_f32_16x16x32_bf16 v[48:51], v[224:227], a[200:203], v[48:51]
    ds_write2_b64 v16, v[84:85], v[88:89] offset0:48 offset1:52
    v_mfma_f32_16x16x32_bf16 v[48:51], a[136:139], a[204:207], v[48:51]
    v_sub_f32 v130, v190, v130
    v_fma_f32 v93, v105, s17, v93
    v_mfma_f32_16x16x32_bf16 v[52:55], v[220:223], a[196:199], v[52:55]
    v_fma_f32 v94, v106, s17, v94
    v_sub_f32 v131, v191, v131
    v_mfma_f32_16x16x32_bf16 v[52:55], a[132:135], a[200:203], v[52:55]
    v_fma_f32 v95, v107, s17, v95
    v_cvt_pk_bf16_f32 v121, v130, v131
    v_mfma_f32_16x16x32_bf16 v[52:55], v[232:235], a[204:207], v[52:55]
    ds_write_b64 v9, v[120:121] offset:28800
    v_cvt_pk_bf16_f32 v92, v92, v93
    v_cvt_pk_bf16_f32 v93, v94, v95
    v_mfma_f32_16x16x32_bf16 v[56:59], a[128:131], a[196:199], v[56:59]
    s_waitcnt vmcnt(10)
    v_lshlrev_b32 v192, 16, v132
    v_and_b32 v193, s16, v132
    v_mfma_f32_16x16x32_bf16 v[56:59], v[228:231], a[200:203], v[56:59]
    v_lshlrev_b32 v194, 16, v133
    v_and_b32 v195, s16, v133
    v_mfma_f32_16x16x32_bf16 v[56:59], a[140:143], a[204:207], v[56:59]
    s_waitcnt lgkmcnt(2)
    ds_write_b64 v16, v[92:93] offset:448
    v_mfma_f32_16x16x32_bf16 v[24:27], v[236:239], a[168:171], v[24:27]
    v_lshlrev_b32 v180, 16, v134
    v_and_b32 v181, s16, v134
    v_mfma_f32_16x16x32_bf16 v[24:27], a[148:151], a[172:175], v[24:27]
    v_lshlrev_b32 v182, 16, v135
    v_and_b32 v183, s16, v135
    v_mfma_f32_16x16x32_bf16 v[24:27], a[156:159], a[176:179], v[24:27]
    buffer_load_dwordx4 v[132:135], v1, s[12:15], s18 offen
    v_sub_f32 v152, v152, v192
    v_mfma_f32_16x16x32_bf16 v[28:31], a[144:147], a[168:171], v[28:31]
    s_waitcnt lgkmcnt(0)
    s_barrier
    v_sub_f32 v153, v153, v193
    v_mfma_f32_16x16x32_bf16 v[28:31], v[244:247], a[172:175], v[28:31]
    ds_read_b128 a[208:211], v17
    v_cvt_pk_bf16_f32 v108, v152, v153
    v_mfma_f32_16x16x32_bf16 v[28:31], a[160:163], a[176:179], v[28:31]
    ds_read_b128 a[212:215], v18
    v_sub_f32 v154, v154, v194
    v_mfma_f32_16x16x32_bf16 v[32:35], v[240:243], a[168:171], v[32:35]
    ds_read_b128 a[188:191], v12 offset:38400
    v_sub_f32 v155, v155, v195
    v_mfma_f32_16x16x32_bf16 v[32:35], a[152:155], a[172:175], v[32:35]
    ds_read_b128 a[192:195], v12 offset:38592
    v_cvt_pk_bf16_f32 v109, v154, v155
    v_mfma_f32_16x16x32_bf16 v[32:35], a[164:167], a[176:179], v[32:35]
    ds_read_b128 a[216:219], v19
    v_sub_f32 v196, v196, v180
    v_mfma_f32_16x16x32_bf16 v[36:39], v[236:239], a[172:175], v[36:39]
    ds_read_b128 a[196:199], v12 offset:38784
    v_sub_f32 v197, v197, v181
    v_mfma_f32_16x16x32_bf16 v[36:39], a[148:151], a[176:179], v[36:39]
    ds_read_b128 a[200:203], v13 offset:38976
    v_cvt_pk_bf16_f32 v110, v196, v197
    v_mfma_f32_16x16x32_bf16 v[36:39], a[156:159], a[180:183], v[36:39]
    ds_read_b128 a[204:207], v13 offset:39168
    v_sub_f32 v198, v198, v182
    v_mfma_f32_16x16x32_bf16 v[40:43], a[144:147], a[172:175], v[40:43]
    ds_read_b128 a[220:223], v20
    v_sub_f32 v199, v199, v183
    v_mfma_f32_16x16x32_bf16 v[40:43], v[244:247], a[176:179], v[40:43]
    ds_read_b128 a[224:227], v21
    v_cvt_pk_bf16_f32 v111, v198, v199
    v_mfma_f32_16x16x32_bf16 v[40:43], a[160:163], a[180:183], v[40:43]
    s_waitcnt lgkmcnt(9)
    v_add_f32 v184, v172, v192
    v_add_f32 v185, v173, v193
    v_mfma_f32_16x16x32_bf16 v[44:47], v[240:243], a[172:175], v[44:47]
    s_waitcnt lgkmcnt(8)
    v_cvt_pk_bf16_f32 v112, v184, v185
    v_add_f32 v186, v174, v194
    v_mfma_f32_16x16x32_bf16 v[44:47], a[152:155], a[176:179], v[44:47]
    ds_write_b128 v14, v[24:27] offset:0
    v_mfma_f32_16x16x32_bf16 v[44:47], a[164:167], a[180:183], v[44:47]
    s_waitcnt lgkmcnt(6)
    v_add_f32 v187, v175, v195
    v_cvt_pk_bf16_f32 v113, v186, v187
    v_mfma_f32_16x16x32_bf16 v[48:51], v[236:239], a[176:179], v[48:51]
    buffer_store_dwordx4 a[208:211], v22, s[24:27], s38 offen offset:0 sc0 sc1
    v_mfma_f32_16x16x32_bf16 v[48:51], a[148:151], a[180:183], v[48:51]
    ds_write_b128 v14, v[28:31] offset:1024
    v_mfma_f32_16x16x32_bf16 v[48:51], a[156:159], a[184:187], v[48:51]
    v_add_f32 v128, v176, v180
    v_add_f32 v129, v177, v181
    v_mfma_f32_16x16x32_bf16 v[52:55], a[144:147], a[176:179], v[52:55]
    s_waitcnt lgkmcnt(3)
    v_cvt_pk_bf16_f32 v114, v128, v129
    v_add_f32 v130, v178, v182
    v_mfma_f32_16x16x32_bf16 v[52:55], v[244:247], a[180:183], v[52:55]
    ds_write_b128 v4, v[108:111] offset:0
    v_mfma_f32_16x16x32_bf16 v[52:55], a[160:163], a[184:187], v[52:55]
    s_waitcnt lgkmcnt(3)
    v_add_f32 v131, v179, v183
    v_cvt_pk_bf16_f32 v115, v130, v131
    v_mfma_f32_16x16x32_bf16 v[56:59], v[240:243], a[176:179], v[56:59]
    v_sub_f32 v152, v172, v192
    v_sub_f32 v153, v173, v193
    v_mfma_f32_16x16x32_bf16 v[56:59], a[152:155], a[180:183], v[56:59]
    ds_write_b128 v14, v[32:35] offset:2048
    v_mfma_f32_16x16x32_bf16 v[56:59], a[164:167], a[184:187], v[56:59]
    v_cvt_pk_bf16_f32 v116, v152, v153
    v_sub_f32 v154, v174, v194
    v_mfma_f32_16x16x32_bf16 v[60:63], a[0:3], a[188:191], v[24:27]
    buffer_store_dwordx4 a[212:215], v22, s[24:27], s38 offen offset:1024 sc0 sc1
    v_mfma_f32_16x16x32_bf16 v[60:63], a[12:15], a[192:195], v[60:63]
    ds_read_b128 a[168:171], v12 offset:38464
    v_sub_f32 v155, v175, v195
    v_mfma_f32_16x16x32_bf16 v[60:63], a[24:27], a[196:199], v[60:63]
    ds_read_b128 a[172:175], v12 offset:38656
    v_cvt_pk_bf16_f32 v117, v154, v155
    v_mfma_f32_16x16x32_bf16 v[64:67], a[4:7], a[188:191], v[28:31]
    ds_read_b128 a[176:179], v12 offset:38848
    v_sub_f32 v196, v176, v180
    v_mfma_f32_16x16x32_bf16 v[64:67], a[16:19], a[192:195], v[64:67]
    ds_read_b128 a[180:183], v13 offset:39040
    v_sub_f32 v197, v177, v181
    v_mfma_f32_16x16x32_bf16 v[64:67], a[28:31], a[196:199], v[64:67]
    ds_read_b128 a[184:187], v13 offset:39232
    v_cvt_pk_bf16_f32 v118, v196, v197
    v_mfma_f32_16x16x32_bf16 v[68:71], a[8:11], a[188:191], v[32:35]
    ds_write_b128 v4, v[112:115] offset:9600
    v_mfma_f32_16x16x32_bf16 v[68:71], a[20:23], a[192:195], v[68:71]
    v_sub_f32 v198, v178, v182
    v_sub_f32 v199, v179, v183
    v_mfma_f32_16x16x32_bf16 v[68:71], a[32:35], a[196:199], v[68:71]
    v_cvt_pk_bf16_f32 v119, v198, v199
    v_mfma_f32_16x16x32_bf16 v[72:75], a[0:3], a[192:195], v[36:39]
    s_waitcnt vmcnt(9)
    v_lshlrev_b32 v184, 16, v136
    v_and_b32 v185, s16, v136
    v_mfma_f32_16x16x32_bf16 v[72:75], a[12:15], a[196:199], v[72:75]
    buffer_store_dwordx4 a[216:219], v22, s[24:27], s38 offen offset:2048 sc0 sc1
    v_mfma_f32_16x16x32_bf16 v[72:75], a[24:27], a[200:203], v[72:75]
    ds_write_b128 v14, v[36:39] offset:3072
    v_mfma_f32_16x16x32_bf16 v[76:79], a[4:7], a[192:195], v[40:43]
    v_lshlrev_b32 v186, 16, v137
    v_and_b32 v187, s16, v137
    v_mfma_f32_16x16x32_bf16 v[76:79], a[16:19], a[196:199], v[76:79]
    v_lshlrev_b32 v128, 16, v138
    v_and_b32 v129, s16, v138
    v_mfma_f32_16x16x32_bf16 v[76:79], a[28:31], a[200:203], v[76:79]
    ds_write_b128 v4, v[116:119] offset:19200
    v_mfma_f32_16x16x32_bf16 v[80:83], a[8:11], a[192:195], v[44:47]
    v_lshlrev_b32 v130, 16, v139
    v_and_b32 v131, s16, v139
    v_mfma_f32_16x16x32_bf16 v[80:83], a[20:23], a[196:199], v[80:83]
    buffer_load_dwordx4 v[136:139], v2, s[12:15], s18 offen
    v_sub_f32 v124, v124, v184
    v_mfma_f32_16x16x32_bf16 v[80:83], a[32:35], a[200:203], v[80:83]
    ds_write_b128 v14, v[40:43] offset:4096
    v_mfma_f32_16x16x32_bf16 v[84:87], a[0:3], a[196:199], v[48:51]
    v_sub_f32 v125, v125, v185
    v_cvt_pk_bf16_f32 v120, v124, v125
    v_mfma_f32_16x16x32_bf16 v[84:87], a[12:15], a[200:203], v[84:87]
    v_sub_f32 v126, v126, v186
    v_sub_f32 v127, v127, v187
    v_mfma_f32_16x16x32_bf16 v[84:87], a[24:27], a[204:207], v[84:87]
    ds_write_b128 v14, v[44:47] offset:5120
    v_mfma_f32_16x16x32_bf16 v[88:91], a[4:7], a[196:199], v[52:55]
    v_cvt_pk_bf16_f32 v121, v126, v127
    v_sub_f32 v164, v164, v128
    v_mfma_f32_16x16x32_bf16 v[88:91], a[16:19], a[200:203], v[88:91]
    buffer_store_dwordx4 a[220:223], v22, s[24:27], s38 offen offset:3072 sc0 sc1
    v_mfma_f32_16x16x32_bf16 v[88:91], a[28:31], a[204:207], v[88:91]
    ds_write_b128 v14, v[48:51] offset:6144
    v_mfma_f32_16x16x32_bf16 v[92:95], a[8:11], a[196:199], v[56:59]
    v_sub_f32 v165, v165, v129
    v_cvt_pk_bf16_f32 v122, v164, v165
    v_mfma_f32_16x16x32_bf16 v[92:95], a[20:23], a[200:203], v[92:95]
    v_sub_f32 v166, v166, v130
    v_sub_f32 v167, v167, v131
    v_mfma_f32_16x16x32_bf16 v[92:95], a[32:35], a[204:207], v[92:95]
    s_waitcnt lgkmcnt(6)
    v_cvt_pk_bf16_f32 v123, v166, v167
    v_add_f32 v152, v156, v184
    v_mfma_f32_16x16x32_bf16 v[60:63], a[36:39], a[168:171], v[60:63]
    ds_write_b128 v5, v[120:123] offset:0
    v_mfma_f32_16x16x32_bf16 v[60:63], a[48:51], a[172:175], v[60:63]
    v_add_f32 v153, v157, v185
    v_cvt_pk_bf16_f32 v108, v152, v153
    v_mfma_f32_16x16x32_bf16 v[60:63], a[60:63], a[176:179], v[60:63]
    v_add_f32 v154, v158, v186
    v_add_f32 v155, v159, v187
    v_mfma_f32_16x16x32_bf16 v[64:67], a[40:43], a[168:171], v[64:67]
    ds_read_b128 a[188:191], v12 offset:38528
    v_cvt_pk_bf16_f32 v109, v154, v155
    v_mfma_f32_16x16x32_bf16 v[64:67], a[52:55], a[172:175], v[64:67]
    ds_read_b128 a[192:195], v12 offset:38720
    v_add_f32 v196, v160, v128
    v_mfma_f32_16x16x32_bf16 v[64:67], a[64:67], a[176:179], v[64:67]
    ds_read_b128 a[196:199], v12 offset:38912
    v_add_f32 v197, v161, v129
    v_mfma_f32_16x16x32_bf16 v[68:71], a[44:47], a[168:171], v[68:71]
    ds_read_b128 a[200:203], v13 offset:39104
    v_cvt_pk_bf16_f32 v110, v196, v197
    v_mfma_f32_16x16x32_bf16 v[68:71], a[56:59], a[172:175], v[68:71]
    ds_read_b128 a[204:207], v13 offset:39296
    v_add_f32 v198, v162, v130
    v_mfma_f32_16x16x32_bf16 v[68:71], a[68:71], a[176:179], v[68:71]
    buffer_store_dwordx4 a[224:227], v23, s[24:27], s38 offen sc0 sc1
    v_mfma_f32_16x16x32_bf16 v[72:75], a[36:39], a[172:175], v[72:75]
    ds_write_b128 v14, v[52:55] offset:7168
    v_mfma_f32_16x16x32_bf16 v[72:75], a[48:51], a[176:179], v[72:75]
    s_add_u32 s38, s38, s98
    v_add_f32 v199, v163, v131
    v_cvt_pk_bf16_f32 v111, v198, v199
    v_mfma_f32_16x16x32_bf16 v[72:75], a[60:63], a[180:183], v[72:75]
    v_sub_f32 v124, v156, v184
    v_sub_f32 v125, v157, v185
    v_mfma_f32_16x16x32_bf16 v[76:79], a[40:43], a[172:175], v[76:79]
    ds_write_b128 v5, v[108:111] offset:9600
    v_mfma_f32_16x16x32_bf16 v[76:79], a[52:55], a[176:179], v[76:79]
    v_cvt_pk_bf16_f32 v112, v124, v125
    v_sub_f32 v126, v158, v186
    v_mfma_f32_16x16x32_bf16 v[76:79], a[64:67], a[180:183], v[76:79]
    v_sub_f32 v127, v159, v187
    v_cvt_pk_bf16_f32 v113, v126, v127
    v_mfma_f32_16x16x32_bf16 v[80:83], a[44:47], a[172:175], v[80:83]
    ds_write_b128 v14, v[56:59] offset:8192
    v_mfma_f32_16x16x32_bf16 v[80:83], a[56:59], a[176:179], v[80:83]
    v_sub_f32 v164, v160, v128
    v_sub_f32 v165, v161, v129
    v_mfma_f32_16x16x32_bf16 v[80:83], a[68:71], a[180:183], v[80:83]
    v_cvt_pk_bf16_f32 v114, v164, v165
    v_sub_f32 v166, v162, v130
    v_mfma_f32_16x16x32_bf16 v[84:87], a[36:39], a[176:179], v[84:87]
    v_sub_f32 v167, v163, v131
    v_cvt_pk_bf16_f32 v115, v166, v167
    v_mfma_f32_16x16x32_bf16 v[84:87], a[48:51], a[180:183], v[84:87]
    s_waitcnt vmcnt(10)
    v_lshlrev_b32 v152, 16, v140
    v_and_b32 v153, s16, v140
    v_mfma_f32_16x16x32_bf16 v[84:87], a[60:63], a[184:187], v[84:87]
    ds_write_b128 v5, v[112:115] offset:19200
    v_mfma_f32_16x16x32_bf16 v[88:91], a[40:43], a[176:179], v[88:91]
    v_lshlrev_b32 v154, 16, v141
    v_and_b32 v155, s16, v141
    v_mfma_f32_16x16x32_bf16 v[88:91], a[52:55], a[180:183], v[88:91]
    buffer_load_dwordx2 v[140:141], v3, s[12:15], s18 offen
    v_sub_f32 v168, v168, v152
    v_mfma_f32_16x16x32_bf16 v[88:91], a[64:67], a[184:187], v[88:91]
    s_add_u32 s18, s18, s98
    v_sub_f32 v169, v169, v153
    v_cvt_pk_bf16_f32 v116, v168, v169
    v_mfma_f32_16x16x32_bf16 v[92:95], a[44:47], a[176:179], v[92:95]
    v_sub_f32 v170, v170, v154
    v_sub_f32 v171, v171, v155
    v_mfma_f32_16x16x32_bf16 v[92:95], a[56:59], a[180:183], v[92:95]
    v_cvt_pk_bf16_f32 v117, v170, v171
    v_add_f32 v196, v188, v152
    v_mfma_f32_16x16x32_bf16 v[92:95], a[68:71], a[184:187], v[92:95]
    s_waitcnt lgkmcnt(4)
    v_add_f32 v197, v189, v153
    v_cvt_pk_bf16_f32 v120, v196, v197
    v_mfma_f32_16x16x32_bf16 v[60:63], a[72:75], a[188:191], v[60:63]
    ds_write_b64 v6, v[116:117] offset:0
    v_mfma_f32_16x16x32_bf16 v[60:63], a[84:87], a[192:195], v[60:63]
    v_add_f32 v198, v190, v154
    v_add_f32 v199, v191, v155
    v_mfma_f32_16x16x32_bf16 v[60:63], a[96:99], a[196:199], v[60:63]
    v_cvt_pk_bf16_f32 v121, v198, v199
    v_sub_f32 v124, v188, v152
    v_mfma_f32_16x16x32_bf16 v[64:67], a[76:79], a[188:191], v[64:67]
    ds_write_b64 v6, v[120:121] offset:9600
    v_sub_f32 v125, v189, v153
    v_cvt_pk_bf16_f32 v108, v124, v125
    v_mfma_f32_16x16x32_bf16 v[64:67], a[88:91], a[192:195], v[64:67]
    v_sub_f32 v126, v190, v154
    v_sub_f32 v127, v191, v155
    v_cvt_pk_bf16_f32 v109, v126, v127
    v_mfma_f32_16x16x32_bf16 v[64:67], a[100:103], a[196:199], v[64:67]
    s_waitcnt vmcnt(10)
    v_lshlrev_b32 v164, 16, v144
    v_and_b32 v165, s16, v144
    v_mfma_f32_16x16x32_bf16 v[68:71], a[80:83], a[188:191], v[68:71]
    ds_write_b64 v6, v[108:109] offset:19200
    v_mfma_f32_16x16x32_bf16 v[68:71], a[92:95], a[192:195], v[68:71]
    v_lshlrev_b32 v166, 16, v145
    v_and_b32 v167, s16, v145
    v_mfma_f32_16x16x32_bf16 v[68:71], a[104:107], a[196:199], v[68:71]
    v_lshlrev_b32 v168, 16, v146
    v_and_b32 v169, s16, v146
    v_mfma_f32_16x16x32_bf16 v[72:75], a[72:75], a[192:195], v[72:75]
    v_lshlrev_b32 v170, 16, v147
    v_and_b32 v171, s16, v147
    v_mfma_f32_16x16x32_bf16 v[72:75], a[84:87], a[196:199], v[72:75]
    buffer_load_dwordx4 v[144:147], v1, s[12:15], s19 offen
    v_sub_f32 v172, v164, v172
    v_mfma_f32_16x16x32_bf16 v[72:75], a[96:99], a[200:203], v[72:75]
    s_waitcnt lgkmcnt(0)
    s_barrier
    v_sub_f32 v173, v165, v173
    v_mfma_f32_16x16x32_bf16 v[76:79], a[76:79], a[192:195], v[76:79]
    ds_read_b128 v[96:99], v15 offset:0
    v_cvt_pk_bf16_f32 v112, v172, v173
    v_mfma_f32_16x16x32_bf16 v[76:79], a[88:91], a[196:199], v[76:79]
    ds_read_b128 a[168:171], v10 offset:0
    v_sub_f32 v174, v166, v174
    v_mfma_f32_16x16x32_bf16 v[76:79], a[100:103], a[200:203], v[76:79]
    ds_read_b128 a[172:175], v10 offset:192
    v_sub_f32 v175, v167, v175
    v_mfma_f32_16x16x32_bf16 v[80:83], a[80:83], a[192:195], v[80:83]
    ds_read_b128 a[176:179], v10 offset:384
    v_cvt_pk_bf16_f32 v113, v174, v175
    v_mfma_f32_16x16x32_bf16 v[80:83], a[92:95], a[196:199], v[80:83]
    ds_read_b128 a[180:183], v11 offset:576
    v_sub_f32 v176, v168, v176
    v_mfma_f32_16x16x32_bf16 v[80:83], a[104:107], a[200:203], v[80:83]
    ds_read_b128 a[184:187], v11 offset:768
    v_sub_f32 v177, v169, v177
    v_mfma_f32_16x16x32_bf16 v[84:87], a[72:75], a[196:199], v[84:87]
    ds_read_b128 v[100:103], v15 offset:1024
    v_cvt_pk_bf16_f32 v114, v176, v177
    v_mfma_f32_16x16x32_bf16 v[84:87], a[84:87], a[200:203], v[84:87]
    ds_read_b128 v[104:107], v15 offset:2048
    v_sub_f32 v178, v170, v178
    v_mfma_f32_16x16x32_bf16 v[84:87], a[96:99], a[204:207], v[84:87]
    v_sub_f32 v179, v171, v179
    v_cvt_pk_bf16_f32 v115, v178, v179
    v_mfma_f32_16x16x32_bf16 v[88:91], a[76:79], a[196:199], v[88:91]
    s_waitcnt vmcnt(10)
    v_lshlrev_b32 v196, 16, v148
    v_and_b32 v197, s16, v148
    v_mfma_f32_16x16x32_bf16 v[88:91], a[88:91], a[200:203], v[88:91]
    s_waitcnt lgkmcnt(7)
    v_fma_f32 v60, v96, s17, v60
    v_fma_f32 v61, v97, s17, v61
    v_mfma_f32_16x16x32_bf16 v[88:91], a[100:103], a[204:207], v[88:91]
    ds_write_b128 v4, v[112:115] offset:28800
    v_mfma_f32_16x16x32_bf16 v[92:95], a[80:83], a[196:199], v[92:95]
    v_fma_f32 v62, v98, s17, v62
    v_fma_f32 v63, v99, s17, v63
    v_mfma_f32_16x16x32_bf16 v[92:95], a[92:95], a[200:203], v[92:95]
    v_cvt_pk_bf16_f32 v60, v60, v61
    v_cvt_pk_bf16_f32 v61, v62, v63
    v_mfma_f32_16x16x32_bf16 v[92:95], a[104:107], a[204:207], v[92:95]
    s_waitcnt lgkmcnt(3)
    v_lshlrev_b32 v198, 16, v149
    v_and_b32 v199, s16, v149
    v_mfma_f32_16x16x32_bf16 v[24:27], v[200:203], a[168:171], 0
    ds_read_b128 v[96:99], v15 offset:3072
    v_lshlrev_b32 v124, 16, v150
    v_mfma_f32_16x16x32_bf16 v[24:27], a[112:115], a[172:175], v[24:27]
    s_waitcnt lgkmcnt(3)
    v_fma_f32 v64, v100, s17, v64
    v_fma_f32 v65, v101, s17, v65
    v_mfma_f32_16x16x32_bf16 v[24:27], v[212:215], a[176:179], v[24:27]
    ds_read_b128 a[188:191], v10 offset:64
    v_fma_f32 v66, v102, s17, v66
    v_mfma_f32_16x16x32_bf16 v[28:31], a[108:111], a[168:171], 0
    ds_read_b128 a[192:195], v10 offset:256
    v_fma_f32 v67, v103, s17, v67
    v_mfma_f32_16x16x32_bf16 v[28:31], v[208:211], a[172:175], v[28:31]
    ds_read_b128 v[100:103], v15 offset:4096
    v_cvt_pk_bf16_f32 v64, v64, v65
    v_mfma_f32_16x16x32_bf16 v[28:31], a[120:123], a[176:179], v[28:31]
    ds_read_b128 a[196:199], v10 offset:448
    v_cvt_pk_bf16_f32 v65, v66, v67
    v_mfma_f32_16x16x32_bf16 v[32:35], v[204:207], a[168:171], 0
    s_waitcnt lgkmcnt(6)
    v_fma_f32 v68, v104, s17, v68
    v_fma_f32 v69, v105, s17, v69
    v_mfma_f32_16x16x32_bf16 v[32:35], a[116:119], a[172:175], v[32:35]
    ds_write2_b64 v16, v[60:61], v[64:65] offset0:0 offset1:4
    v_mfma_f32_16x16x32_bf16 v[32:35], v[216:219], a[176:179], v[32:35]
    v_fma_f32 v70, v106, s17, v70
    v_fma_f32 v71, v107, s17, v71
    v_mfma_f32_16x16x32_bf16 v[36:39], v[200:203], a[172:175], 0
    v_cvt_pk_bf16_f32 v68, v68, v69
    v_cvt_pk_bf16_f32 v69, v70, v71
    v_mfma_f32_16x16x32_bf16 v[36:39], a[112:115], a[176:179], v[36:39]
    s_waitcnt lgkmcnt(5)
    v_and_b32 v125, s16, v150
    v_fma_f32 v72, v96, s17, v72
    v_mfma_f32_16x16x32_bf16 v[36:39], v[212:215], a[180:183], v[36:39]
    ds_read_b128 v[104:107], v15 offset:5120
    v_lshlrev_b32 v126, 16, v151
    v_mfma_f32_16x16x32_bf16 v[40:43], a[108:111], a[172:175], 0
    ds_read_b128 a[200:203], v11 offset:640
    v_fma_f32 v73, v97, s17, v73
    v_mfma_f32_16x16x32_bf16 v[40:43], v[208:211], a[176:179], v[40:43]
    ds_read_b128 a[204:207], v11 offset:832
    v_and_b32 v127, s16, v151
    v_mfma_f32_16x16x32_bf16 v[40:43], a[120:123], a[180:183], v[40:43]
    buffer_load_dwordx4 v[148:151], v2, s[12:15], s19 offen
    v_fma_f32 v74, v98, s17, v74
    v_mfma_f32_16x16x32_bf16 v[44:47], v[204:207], a[172:175], 0
    v_fma_f32 v75, v99, s17, v75
    v_sub_f32 v156, v196, v156
    v_mfma_f32_16x16x32_bf16 v[44:47], a[116:119], a[176:179], v[44:47]
    ds_read_b128 v[96:99], v15 offset:6144
    v_cvt_pk_bf16_f32 v72, v72, v73
    v_mfma_f32_16x16x32_bf16 v[44:47], v[216:219], a[180:183], v[44:47]
    v_sub_f32 v157, v197, v157
    v_cvt_pk_bf16_f32 v73, v74, v75
    v_mfma_f32_16x16x32_bf16 v[48:51], v[200:203], a[176:179], 0
    s_waitcnt lgkmcnt(6)
    v_cvt_pk_bf16_f32 v116, v156, v157
    v_fma_f32 v76, v100, s17, v76
    v_mfma_f32_16x16x32_bf16 v[48:51], a[112:115], a[180:183], v[48:51]
L_stub4:
    s_cbranch_execz L_back
    ds_write2_b64 v16, v[68:69], v[72:73] offset0:8 offset1:24
    v_mfma_f32_16x16x32_bf16 v[48:51], v[212:215], a[184:187], v[48:51]
    v_fma_f32 v77, v101, s17, v77
    v_sub_f32 v158, v198, v158
    v_mfma_f32_16x16x32_bf16 v[52:55], a[108:111], a[176:179], 0
    v_fma_f32 v78, v102, s17, v78
    v_sub_f32 v159, v199, v159
    v_mfma_f32_16x16x32_bf16 v[52:55], v[208:211], a[180:183], v[52:55]
    v_fma_f32 v79, v103, s17, v79
    v_cvt_pk_bf16_f32 v76, v76, v77
    v_mfma_f32_16x16x32_bf16 v[52:55], a[120:123], a[184:187], v[52:55]
    ds_read_b128 v[100:103], v15 offset:7168
    v_cvt_pk_bf16_f32 v117, v158, v159
    v_mfma_f32_16x16x32_bf16 v[56:59], v[204:207], a[176:179], 0
    v_cvt_pk_bf16_f32 v77, v78, v79
    v_sub_f32 v160, v124, v160
    v_mfma_f32_16x16x32_bf16 v[56:59], a[116:119], a[180:183], v[56:59]
    s_waitcnt lgkmcnt(5)
    v_fma_f32 v80, v104, s17, v80
    v_sub_f32 v161, v125, v161
    v_mfma_f32_16x16x32_bf16 v[56:59], v[216:219], a[184:187], v[56:59]
    s_waitcnt lgkmcnt(3)
    v_fma_f32 v81, v105, s17, v81
    v_fma_f32 v82, v106, s17, v82
    v_mfma_f32_16x16x32_bf16 v[24:27], a[124:127], a[188:191], v[24:27]
    v_cvt_pk_bf16_f32 v118, v160, v161
    v_fma_f32 v83, v107, s17, v83
    v_mfma_f32_16x16x32_bf16 v[24:27], v[224:227], a[192:195], v[24:27]
    ds_read_b128 v[104:107], v15 offset:8192
    v_sub_f32 v162, v126, v162
    v_mfma_f32_16x16x32_bf16 v[24:27], a[136:139], a[196:199], v[24:27]
    ds_read_b128 a[168:171], v10 offset:128
    v_cvt_pk_bf16_f32 v80, v80, v81
    v_mfma_f32_16x16x32_bf16 v[28:31], v[220:223], a[188:191], v[28:31]
    ds_read_b128 a[172:175], v10 offset:320
    v_cvt_pk_bf16_f32 v81, v82, v83
    v_mfma_f32_16x16x32_bf16 v[28:31], a[132:135], a[192:195], v[28:31]
    s_waitcnt lgkmcnt(5)
    v_sub_f32 v163, v127, v163
    v_fma_f32 v84, v96, s17, v84
    v_mfma_f32_16x16x32_bf16 v[28:31], v[232:235], a[196:199], v[28:31]
    ds_write2_b64 v16, v[76:77], v[80:81] offset0:28 offset1:32
    v_mfma_f32_16x16x32_bf16 v[32:35], a[128:131], a[188:191], v[32:35]
    v_cvt_pk_bf16_f32 v119, v162, v163
    v_fma_f32 v85, v97, s17, v85
    v_mfma_f32_16x16x32_bf16 v[32:35], v[228:231], a[192:195], v[32:35]
    s_waitcnt vmcnt(10)
    v_fma_f32 v86, v98, s17, v86
    v_fma_f32 v87, v99, s17, v87
    v_mfma_f32_16x16x32_bf16 v[32:35], a[140:143], a[196:199], v[32:35]
    ds_write_b128 v5, v[116:119] offset:28800
    v_mfma_f32_16x16x32_bf16 v[36:39], a[124:127], a[192:195], v[36:39]
    v_lshlrev_b32 v172, 16, v142
    v_cvt_pk_bf16_f32 v84, v84, v85
    v_mfma_f32_16x16x32_bf16 v[36:39], v[224:227], a[196:199], v[36:39]
    v_and_b32 v173, s16, v142
    v_cvt_pk_bf16_f32 v85, v86, v87
    v_mfma_f32_16x16x32_bf16 v[36:39], a[136:139], a[200:203], v[36:39]
    s_waitcnt lgkmcnt(5)
    v_lshlrev_b32 v174, 16, v143
    v_fma_f32 v88, v100, s17, v88
    v_mfma_f32_16x16x32_bf16 v[40:43], v[220:223], a[192:195], v[40:43]
    ds_read_b128 a[176:179], v10 offset:512
    v_fma_f32 v89, v101, s17, v89
    v_mfma_f32_16x16x32_bf16 v[40:43], a[132:135], a[196:199], v[40:43]
    ds_read_b128 a[180:183], v11 offset:704
    v_and_b32 v175, s16, v143
    v_mfma_f32_16x16x32_bf16 v[40:43], v[232:235], a[200:203], v[40:43]
    ds_read_b128 a[184:187], v11 offset:896
    v_fma_f32 v90, v102, s17, v90
    v_mfma_f32_16x16x32_bf16 v[44:47], a[128:131], a[192:195], v[44:47]
    buffer_load_dwordx2 v[142:143], v3, s[12:15], s19 offen
    v_sub_f32 v188, v172, v188
    v_mfma_f32_16x16x32_bf16 v[44:47], v[228:231], a[196:199], v[44:47]
    s_add_u32 s19, s19, s98
    v_fma_f32 v91, v103, s17, v91
    v_cvt_pk_bf16_f32 v88, v88, v89
    v_mfma_f32_16x16x32_bf16 v[44:47], a[140:143], a[200:203], v[44:47]
    v_sub_f32 v189, v173, v189
    v_cvt_pk_bf16_f32 v89, v90, v91
    v_mfma_f32_16x16x32_bf16 v[48:51], a[124:127], a[196:199], v[48:51]
    s_waitcnt lgkmcnt(7)
    v_cvt_pk_bf16_f32 v120, v188, v189
    v_fma_f32 v92, v104, s17, v92
    v_mfma_f32_16x16x32_bf16 v[48:51], v[224:227], a[200:203], v[48:51]
    ds_write2_b64 v16, v[84:85], v[88:89] offset0:48 offset1:52
    v_mfma_f32_16x16x32_bf16 v[48:51], a[136:139], a[204:207], v[48:51]
    v_sub_f32 v190, v174, v190
    v_fma_f32 v93, v105, s17, v93
    v_mfma_f32_16x16x32_bf16 v[52:55], v[220:223], a[196:199], v[52:55]
    v_fma_f32 v94, v106, s17, v94
    v_sub_f32 v191, v175, v191
    v_mfma_f32_16x16x32_bf16 v[52:55], a[132:135], a[200:203], v[52:55]
    v_fma_f32 v95, v107, s17, v95
    v_cvt_pk_bf16_f32 v121, v190, v191
    v_mfma_f32_16x16x32_bf16 v[52:55], v[232:235], a[204:207], v[52:55]
    ds_write_b64 v6, v[120:121] offset:28800
    v_cvt_pk_bf16_f32 v92, v92, v93
    v_cvt_pk_bf16_f32 v93, v94, v95
    v_mfma_f32_16x16x32_bf16 v[56:59], a[128:131], a[196:199], v[56:59]
    s_waitcnt vmcnt(10)
    v_lshlrev_b32 v176, 16, v132
    v_and_b32 v177, s16, v132
    v_mfma_f32_16x16x32_bf16 v[56:59], v[228:231], a[200:203], v[56:59]
    v_lshlrev_b32 v178, 16, v133
    v_and_b32 v179, s16, v133
    v_mfma_f32_16x16x32_bf16 v[56:59], a[140:143], a[204:207], v[56:59]
    s_waitcnt lgkmcnt(2)
    ds_write_b64 v16, v[92:93] offset:448
    v_mfma_f32_16x16x32_bf16 v[24:27], v[236:239], a[168:171], v[24:27]
    v_lshlrev_b32 v156, 16, v134
    v_and_b32 v157, s16, v134
    v_mfma_f32_16x16x32_bf16 v[24:27], a[148:151], a[172:175], v[24:27]
    v_lshlrev_b32 v158, 16, v135
    v_and_b32 v159, s16, v135
    v_mfma_f32_16x16x32_bf16 v[24:27], a[156:159], a[176:179], v[24:27]
    v_sub_f32 v192, v192, v176
    v_sub_f32 v193, v193, v177
    v_mfma_f32_16x16x32_bf16 v[28:31], a[144:147], a[168:171], v[28:31]
    s_waitcnt lgkmcnt(0)
    s_barrier
    v_cvt_pk_bf16_f32 v108, v192, v193
    v_mfma_f32_16x16x32_bf16 v[28:31], v[244:247], a[172:175], v[28:31]
    ds_read_b128 a[208:211], v17
    v_sub_f32 v194, v194, v178
    v_mfma_f32_16x16x32_bf16 v[28:31], a[160:163], a[176:179], v[28:31]
    ds_read_b128 a[212:215], v18
    v_sub_f32 v195, v195, v179
    v_mfma_f32_16x16x32_bf16 v[32:35], v[240:243], a[168:171], v[32:35]
    ds_read_b128 a[188:191], v12 offset:0
    v_cvt_pk_bf16_f32 v109, v194, v195
    v_mfma_f32_16x16x32_bf16 v[32:35], a[152:155], a[172:175], v[32:35]
    ds_read_b128 a[192:195], v12 offset:192
    v_sub_f32 v180, v180, v156
    v_mfma_f32_16x16x32_bf16 v[32:35], a[164:167], a[176:179], v[32:35]
    ds_read_b128 a[216:219], v19
    v_sub_f32 v181, v181, v157
    v_mfma_f32_16x16x32_bf16 v[36:39], v[236:239], a[172:175], v[36:39]
    ds_read_b128 a[196:199], v12 offset:384
    v_cvt_pk_bf16_f32 v110, v180, v181
    v_mfma_f32_16x16x32_bf16 v[36:39], a[148:151], a[176:179], v[36:39]
    ds_read_b128 a[200:203], v13 offset:576
    v_sub_f32 v182, v182, v158
    v_mfma_f32_16x16x32_bf16 v[36:39], a[156:159], a[180:183], v[36:39]
    ds_read_b128 a[204:207], v13 offset:768
    v_sub_f32 v183, v183, v159
    v_mfma_f32_16x16x32_bf16 v[40:43], a[144:147], a[172:175], v[40:43]
    ds_read_b128 a[220:223], v20
    v_cvt_pk_bf16_f32 v111, v182, v183
    v_mfma_f32_16x16x32_bf16 v[40:43], v[244:247], a[176:179], v[40:43]
    ds_read_b128 a[224:227], v21
    v_add_f32 v160, v164, v176
    v_mfma_f32_16x16x32_bf16 v[40:43], a[160:163], a[180:183], v[40:43]
    s_waitcnt lgkmcnt(9)
    v_add_f32 v161, v165, v177
    v_cvt_pk_bf16_f32 v112, v160, v161
    v_mfma_f32_16x16x32_bf16 v[44:47], v[240:243], a[172:175], v[44:47]
    s_waitcnt lgkmcnt(8)
    v_add_f32 v162, v166, v178
    v_add_f32 v163, v167, v179
    v_mfma_f32_16x16x32_bf16 v[44:47], a[152:155], a[176:179], v[44:47]
    ds_write_b128 v14, v[24:27] offset:0
    v_mfma_f32_16x16x32_bf16 v[44:47], a[164:167], a[180:183], v[44:47]
    s_waitcnt lgkmcnt(6)
    v_cvt_pk_bf16_f32 v113, v162, v163
    v_add_f32 v188, v168, v156
    v_mfma_f32_16x16x32_bf16 v[48:51], v[236:239], a[176:179], v[48:51]
    buffer_store_dwordx4 a[208:211], v22, s[24:27], s38 offen offset:0 sc0 sc1
    v_mfma_f32_16x16x32_bf16 v[48:51], a[148:151], a[180:183], v[48:51]
    ds_write_b128 v14, v[28:31] offset:1024
    v_mfma_f32_16x16x32_bf16 v[48:51], a[156:159], a[184:187], v[48:51]
    v_add_f32 v189, v169, v157
    v_cvt_pk_bf16_f32 v114, v188, v189
    v_mfma_f32_16x16x32_bf16 v[52:55], a[144:147], a[176:179], v[52:55]
    s_waitcnt lgkmcnt(3)
    v_add_f32 v190, v170, v158
    v_add_f32 v191, v171, v159
    v_mfma_f32_16x16x32_bf16 v[52:55], v[244:247], a[180:183], v[52:55]
    ds_write_b128 v7, v[108:111] offset:0
    v_mfma_f32_16x16x32_bf16 v[52:55], a[160:163], a[184:187], v[52:55]
    s_waitcnt lgkmcnt(3)
    v_cvt_pk_bf16_f32 v115, v190, v191
    v_sub_f32 v192, v164, v176
    v_mfma_f32_16x16x32_bf16 v[56:59], v[240:243], a[176:179], v[56:59]
    v_sub_f32 v193, v165, v177
    v_cvt_pk_bf16_f32 v116, v192, v193
    v_mfma_f32_16x16x32_bf16 v[56:59], a[152:155], a[180:183], v[56:59]
    ds_write_b128 v14, v[32:35] offset:2048
    v_mfma_f32_16x16x32_bf16 v[56:59], a[164:167], a[184:187], v[56:59]
    v_sub_f32 v194, v166, v178
    v_sub_f32 v195, v167, v179
    v_mfma_f32_16x16x32_bf16 v[60:63], a[0:3], a[188:191], v[24:27]
    buffer_store_dwordx4 a[212:215], v22, s[24:27], s38 offen offset:1024 sc0 sc1
    v_mfma_f32_16x16x32_bf16 v[60:63], a[12:15], a[192:195], v[60:63]
    ds_read_b128 a[168:171], v12 offset:64
    v_cvt_pk_bf16_f32 v117, v194, v195
    v_mfma_f32_16x16x32_bf16 v[60:63], a[24:27], a[196:199], v[60:63]
    ds_read_b128 a[172:175], v12 offset:256
    v_sub_f32 v180, v168, v156
    v_mfma_f32_16x16x32_bf16 v[64:67], a[4:7], a[188:191], v[28:31]
    ds_read_b128 a[176:179], v12 offset:448
    v_sub_f32 v181, v169, v157
    v_mfma_f32_16x16x32_bf16 v[64:67], a[16:19], a[192:195], v[64:67]
    ds_read_b128 a[180:183], v13 offset:640
    v_cvt_pk_bf16_f32 v118, v180, v181
    v_mfma_f32_16x16x32_bf16 v[64:67], a[28:31], a[196:199], v[64:67]
    ds_read_b128 a[184:187], v13 offset:832
    v_sub_f32 v182, v170, v158
    v_mfma_f32_16x16x32_bf16 v[68:71], a[8:11], a[188:191], v[32:35]
    ds_write_b128 v7, v[112:115] offset:9600
    v_mfma_f32_16x16x32_bf16 v[68:71], a[20:23], a[192:195], v[68:71]
    v_sub_f32 v183, v171, v159
    v_cvt_pk_bf16_f32 v119, v182, v183
    v_mfma_f32_16x16x32_bf16 v[68:71], a[32:35], a[196:199], v[68:71]
    s_waitcnt vmcnt(8)
    v_lshlrev_b32 v160, 16, v136
    v_and_b32 v161, s16, v136
    v_mfma_f32_16x16x32_bf16 v[72:75], a[0:3], a[192:195], v[36:39]
    ds_write_b128 v14, v[36:39] offset:3072
    v_mfma_f32_16x16x32_bf16 v[72:75], a[12:15], a[196:199], v[72:75]
    v_lshlrev_b32 v162, 16, v137
    v_and_b32 v163, s16, v137
    v_mfma_f32_16x16x32_bf16 v[72:75], a[24:27], a[200:203], v[72:75]
    buffer_store_dwordx4 a[216:219], v22, s[24:27], s38 offen offset:2048 sc0 sc1
    v_mfma_f32_16x16x32_bf16 v[76:79], a[4:7], a[192:195], v[40:43]
    ds_write_b128 v7, v[116:119] offset:19200
    v_mfma_f32_16x16x32_bf16 v[76:79], a[16:19], a[196:199], v[76:79]
    v_lshlrev_b32 v188, 16, v138
    v_and_b32 v189, s16, v138
    v_mfma_f32_16x16x32_bf16 v[76:79], a[28:31], a[200:203], v[76:79]
    v_lshlrev_b32 v190, 16, v139
    v_and_b32 v191, s16, v139
    v_mfma_f32_16x16x32_bf16 v[80:83], a[8:11], a[192:195], v[44:47]
    ds_write_b128 v14, v[40:43] offset:4096
    v_mfma_f32_16x16x32_bf16 v[80:83], a[20:23], a[196:199], v[80:83]
    v_sub_f32 v184, v184, v160
    v_sub_f32 v185, v185, v161
    v_mfma_f32_16x16x32_bf16 v[80:83], a[32:35], a[200:203], v[80:83]
    v_cvt_pk_bf16_f32 v120, v184, v185
    v_sub_f32 v186, v186, v162
    v_mfma_f32_16x16x32_bf16 v[84:87], a[0:3], a[196:199], v[48:51]
    ds_write_b128 v14, v[44:47] offset:5120
    v_mfma_f32_16x16x32_bf16 v[84:87], a[12:15], a[200:203], v[84:87]
    v_sub_f32 v187, v187, v163
    v_cvt_pk_bf16_f32 v121, v186, v187
    v_mfma_f32_16x16x32_bf16 v[84:87], a[24:27], a[204:207], v[84:87]
    buffer_store_dwordx4 a[220:223], v22, s[24:27], s38 offen offset:3072 sc0 sc1
    v_mfma_f32_16x16x32_bf16 v[88:91], a[4:7], a[196:199], v[52:55]
    ds_write_b128 v14, v[48:51] offset:6144
    v_mfma_f32_16x16x32_bf16 v[88:91], a[16:19], a[200:203], v[88:91]
    v_sub_f32 v128, v128, v188
    v_sub_f32 v129, v129, v189
    v_mfma_f32_16x16x32_bf16 v[88:91], a[28:31], a[204:207], v[88:91]
    v_cvt_pk_bf16_f32 v122, v128, v129
    v_sub_f32 v130, v130, v190
    v_mfma_f32_16x16x32_bf16 v[92:95], a[8:11], a[196:199], v[56:59]
    ds_write_b128 v14, v[52:55] offset:7168
    v_mfma_f32_16x16x32_bf16 v[92:95], a[20:23], a[200:203], v[92:95]
    v_sub_f32 v131, v131, v191
    v_cvt_pk_bf16_f32 v123, v130, v131
    v_mfma_f32_16x16x32_bf16 v[92:95], a[32:35], a[204:207], v[92:95]
    s_waitcnt lgkmcnt(7)
    v_add_f32 v192, v196, v160
    v_add_f32 v193, v197, v161
    v_mfma_f32_16x16x32_bf16 v[60:63], a[36:39], a[168:171], v[60:63]
    ds_write_b128 v8, v[120:123] offset:0
    v_mfma_f32_16x16x32_bf16 v[60:63], a[48:51], a[172:175], v[60:63]
    v_cvt_pk_bf16_f32 v108, v192, v193
    v_add_f32 v194, v198, v162
    v_mfma_f32_16x16x32_bf16 v[60:63], a[60:63], a[176:179], v[60:63]
    v_add_f32 v195, v199, v163
    v_cvt_pk_bf16_f32 v109, v194, v195
    v_mfma_f32_16x16x32_bf16 v[64:67], a[40:43], a[168:171], v[64:67]
    ds_read_b128 a[188:191], v12 offset:128
    v_add_f32 v180, v124, v188
    v_mfma_f32_16x16x32_bf16 v[64:67], a[52:55], a[172:175], v[64:67]
    ds_read_b128 a[192:195], v12 offset:320
    v_add_f32 v181, v125, v189
    v_mfma_f32_16x16x32_bf16 v[64:67], a[64:67], a[176:179], v[64:67]
    ds_read_b128 a[196:199], v12 offset:512
    v_cvt_pk_bf16_f32 v110, v180, v181
    v_mfma_f32_16x16x32_bf16 v[68:71], a[44:47], a[168:171], v[68:71]
    ds_read_b128 a[200:203], v13 offset:704
    v_add_f32 v182, v126, v190
    v_mfma_f32_16x16x32_bf16 v[68:71], a[56:59], a[172:175], v[68:71]
    ds_read_b128 a[204:207], v13 offset:896
    v_add_f32 v183, v127, v191
    v_mfma_f32_16x16x32_bf16 v[68:71], a[68:71], a[176:179], v[68:71]
    buffer_store_dwordx4 a[224:227], v23, s[24:27], s38 offen sc0 sc1
    v_mfma_f32_16x16x32_bf16 v[72:75], a[36:39], a[172:175], v[72:75]
    s_add_u32 s38, s38, s98
    v_cvt_pk_bf16_f32 v111, v182, v183
    v_sub_f32 v184, v196, v160
    v_mfma_f32_16x16x32_bf16 v[72:75], a[48:51], a[176:179], v[72:75]
    ds_write_b128 v8, v[108:111] offset:9600
    v_mfma_f32_16x16x32_bf16 v[72:75], a[60:63], a[180:183], v[72:75]
    v_sub_f32 v185, v197, v161
    v_cvt_pk_bf16_f32 v112, v184, v185
    v_mfma_f32_16x16x32_bf16 v[76:79], a[40:43], a[172:175], v[76:79]
    v_sub_f32 v186, v198, v162
    v_sub_f32 v187, v199, v163
    v_mfma_f32_16x16x32_bf16 v[76:79], a[52:55], a[176:179], v[76:79]
    ds_write_b128 v14, v[56:59] offset:8192
    v_mfma_f32_16x16x32_bf16 v[76:79], a[64:67], a[180:183], v[76:79]
    v_cvt_pk_bf16_f32 v113, v186, v187
    v_sub_f32 v128, v124, v188
    v_mfma_f32_16x16x32_bf16 v[80:83], a[44:47], a[172:175], v[80:83]
    v_sub_f32 v129, v125, v189
    v_cvt_pk_bf16_f32 v114, v128, v129
    v_mfma_f32_16x16x32_bf16 v[80:83], a[56:59], a[176:179], v[80:83]
    v_sub_f32 v130, v126, v190
    v_sub_f32 v131, v127, v191
    v_mfma_f32_16x16x32_bf16 v[80:83], a[68:71], a[180:183], v[80:83]
    v_cvt_pk_bf16_f32 v115, v130, v131
    v_mfma_f32_16x16x32_bf16 v[84:87], a[36:39], a[176:179], v[84:87]
    s_waitcnt vmcnt(8)
    v_lshlrev_b32 v192, 16, v140
    v_and_b32 v193, s16, v140
    v_mfma_f32_16x16x32_bf16 v[84:87], a[48:51], a[180:183], v[84:87]
    ds_write_b128 v8, v[112:115] offset:19200
    v_mfma_f32_16x16x32_bf16 v[84:87], a[60:63], a[184:187], v[84:87]
    v_lshlrev_b32 v194, 16, v141
    v_and_b32 v195, s16, v141
    v_mfma_f32_16x16x32_bf16 v[88:91], a[40:43], a[176:179], v[88:91]
    v_sub_f32 v152, v152, v192
    v_sub_f32 v153, v153, v193
    v_mfma_f32_16x16x32_bf16 v[88:91], a[52:55], a[180:183], v[88:91]
    v_cvt_pk_bf16_f32 v116, v152, v153
    v_sub_f32 v154, v154, v194
    v_mfma_f32_16x16x32_bf16 v[88:91], a[64:67], a[184:187], v[88:91]
    v_sub_f32 v155, v155, v195
    v_cvt_pk_bf16_f32 v117, v154, v155
    v_mfma_f32_16x16x32_bf16 v[92:95], a[44:47], a[176:179], v[92:95]
    ds_write_b64 v9, v[116:117] offset:0
    v_mfma_f32_16x16x32_bf16 v[92:95], a[56:59], a[180:183], v[92:95]
    v_add_f32 v180, v172, v192
    v_add_f32 v181, v173, v193
    v_mfma_f32_16x16x32_bf16 v[92:95], a[68:71], a[184:187], v[92:95]
    s_waitcnt lgkmcnt(4)
    v_cvt_pk_bf16_f32 v120, v180, v181
    v_add_f32 v182, v174, v194
    v_mfma_f32_16x16x32_bf16 v[60:63], a[72:75], a[188:191], v[60:63]
    v_add_f32 v183, v175, v195
    v_cvt_pk_bf16_f32 v121, v182, v183
    v_mfma_f32_16x16x32_bf16 v[60:63], a[84:87], a[192:195], v[60:63]
    ds_write_b64 v9, v[120:121] offset:9600
    v_mfma_f32_16x16x32_bf16 v[60:63], a[96:99], a[196:199], v[60:63]
    v_sub_f32 v184, v172, v192
    v_sub_f32 v185, v173, v193
    v_mfma_f32_16x16x32_bf16 v[64:67], a[76:79], a[188:191], v[64:67]
    v_cvt_pk_bf16_f32 v108, v184, v185
    v_sub_f32 v186, v174, v194
    v_mfma_f32_16x16x32_bf16 v[64:67], a[88:91], a[192:195], v[64:67]
    v_sub_f32 v187, v175, v195
    v_cvt_pk_bf16_f32 v109, v186, v187
    v_mfma_f32_16x16x32_bf16 v[64:67], a[100:103], a[196:199], v[64:67]
    s_waitcnt vmcnt(7)
    v_lshlrev_b32 v128, 16, v144
    v_and_b32 v129, s16, v144
    v_mfma_f32_16x16x32_bf16 v[68:71], a[80:83], a[188:191], v[68:71]
    ds_write_b64 v9, v[108:109] offset:19200
    v_mfma_f32_16x16x32_bf16 v[68:71], a[92:95], a[192:195], v[68:71]
    v_lshlrev_b32 v130, 16, v145
    v_and_b32 v131, s16, v145
    v_mfma_f32_16x16x32_bf16 v[68:71], a[104:107], a[196:199], v[68:71]
    v_lshlrev_b32 v152, 16, v146
    v_and_b32 v153, s16, v146
    v_mfma_f32_16x16x32_bf16 v[72:75], a[72:75], a[192:195], v[72:75]
    v_lshlrev_b32 v154, 16, v147
    v_and_b32 v155, s16, v147
    v_mfma_f32_16x16x32_bf16 v[72:75], a[84:87], a[196:199], v[72:75]
    v_sub_f32 v164, v128, v164
    v_sub_f32 v165, v129, v165
    v_mfma_f32_16x16x32_bf16 v[72:75], a[96:99], a[200:203], v[72:75]
    s_waitcnt lgkmcnt(0)
    s_barrier
    v_cvt_pk_bf16_f32 v112, v164, v165
    v_mfma_f32_16x16x32_bf16 v[76:79], a[76:79], a[192:195], v[76:79]
    ds_read_b128 v[96:99], v15 offset:0
    v_sub_f32 v166, v130, v166
    v_mfma_f32_16x16x32_bf16 v[76:79], a[88:91], a[196:199], v[76:79]
    ds_read_b128 a[168:171], v10 offset:38400
    v_sub_f32 v167, v131, v167
    v_mfma_f32_16x16x32_bf16 v[76:79], a[100:103], a[200:203], v[76:79]
    ds_read_b128 a[172:175], v10 offset:38592
    v_cvt_pk_bf16_f32 v113, v166, v167
    v_mfma_f32_16x16x32_bf16 v[80:83], a[80:83], a[192:195], v[80:83]
    ds_read_b128 a[176:179], v10 offset:38784
    v_sub_f32 v168, v152, v168
    v_mfma_f32_16x16x32_bf16 v[80:83], a[92:95], a[196:199], v[80:83]
    ds_read_b128 a[180:183], v11 offset:38976
    v_sub_f32 v169, v153, v169
    v_mfma_f32_16x16x32_bf16 v[80:83], a[104:107], a[200:203], v[80:83]
    ds_read_b128 a[184:187], v11 offset:39168
    v_cvt_pk_bf16_f32 v114, v168, v169
    v_mfma_f32_16x16x32_bf16 v[84:87], a[72:75], a[196:199], v[84:87]
    ds_read_b128 v[100:103], v15 offset:1024
    v_sub_f32 v170, v154, v170
    v_mfma_f32_16x16x32_bf16 v[84:87], a[84:87], a[200:203], v[84:87]
    ds_read_b128 v[104:107], v15 offset:2048
    v_sub_f32 v171, v155, v171
    v_mfma_f32_16x16x32_bf16 v[84:87], a[96:99], a[204:207], v[84:87]
    v_cvt_pk_bf16_f32 v115, v170, v171
    v_mfma_f32_16x16x32_bf16 v[88:91], a[76:79], a[196:199], v[88:91]
    s_waitcnt vmcnt(6)
    v_lshlrev_b32 v180, 16, v148
    v_and_b32 v181, s16, v148
    v_mfma_f32_16x16x32_bf16 v[88:91], a[88:91], a[200:203], v[88:91]
    s_waitcnt lgkmcnt(7)
    v_fma_f32 v60, v96, s17, v60
    v_fma_f32 v61, v97, s17, v61
    v_mfma_f32_16x16x32_bf16 v[88:91], a[100:103], a[204:207], v[88:91]
    ds_write_b128 v7, v[112:115] offset:28800
    v_mfma_f32_16x16x32_bf16 v[92:95], a[80:83], a[196:199], v[92:95]
    v_fma_f32 v62, v98, s17, v62
    v_fma_f32 v63, v99, s17, v63
    v_mfma_f32_16x16x32_bf16 v[92:95], a[92:95], a[200:203], v[92:95]
    v_cvt_pk_bf16_f32 v60, v60, v61
    v_cvt_pk_bf16_f32 v61, v62, v63
    v_mfma_f32_16x16x32_bf16 v[92:95], a[104:107], a[204:207], v[92:95]
    s_waitcnt lgkmcnt(3)
    v_lshlrev_b32 v182, 16, v149
    v_and_b32 v183, s16, v149
    v_mfma_f32_16x16x32_bf16 v[24:27], v[200:203], a[168:171], 0
    ds_read_b128 v[96:99], v15 offset:3072
    v_lshlrev_b32 v184, 16, v150
    v_mfma_f32_16x16x32_bf16 v[24:27], a[112:115], a[172:175], v[24:27]
    s_waitcnt lgkmcnt(3)
    v_fma_f32 v64, v100, s17, v64
    v_fma_f32 v65, v101, s17, v65
    v_mfma_f32_16x16x32_bf16 v[24:27], v[212:215], a[176:179], v[24:27]
    ds_read_b128 a[188:191], v10 offset:38464
    v_fma_f32 v66, v102, s17, v66
    v_mfma_f32_16x16x32_bf16 v[28:31], a[108:111], a[168:171], 0
    ds_read_b128 a[192:195], v10 offset:38656
    v_fma_f32 v67, v103, s17, v67
    v_mfma_f32_16x16x32_bf16 v[28:31], v[208:211], a[172:175], v[28:31]
    ds_read_b128 v[100:103], v15 offset:4096
    v_cvt_pk_bf16_f32 v64, v64, v65
    v_mfma_f32_16x16x32_bf16 v[28:31], a[120:123], a[176:179], v[28:31]
    ds_read_b128 a[196:199], v10 offset:38848
    v_cvt_pk_bf16_f32 v65, v66, v67
    v_mfma_f32_16x16x32_bf16 v[32:35], v[204:207], a[168:171], 0
    s_waitcnt lgkmcnt(6)
    v_fma_f32 v68, v104, s17, v68
    v_fma_f32 v69, v105, s17, v69
    v_mfma_f32_16x16x32_bf16 v[32:35], a[116:119], a[172:175], v[32:35]
    ds_write2_b64 v16, v[60:61], v[64:65] offset0:0 offset1:4
    v_mfma_f32_16x16x32_bf16 v[32:35], v[216:219], a[176:179], v[32:35]
    v_fma_f32 v70, v106, s17, v70
    v_fma_f32 v71, v107, s17, v71
    v_mfma_f32_16x16x32_bf16 v[36:39], v[200:203], a[172:175], 0
    v_cvt_pk_bf16_f32 v68, v68, v69
    v_cvt_pk_bf16_f32 v69, v70, v71
    v_mfma_f32_16x16x32_bf16 v[36:39], a[112:115], a[176:179], v[36:39]
    s_waitcnt lgkmcnt(5)
    v_and_b32 v185, s16, v150
    v_fma_f32 v72, v96, s17, v72
    v_mfma_f32_16x16x32_bf16 v[36:39], v[212:215], a[180:183], v[36:39]
    ds_read_b128 v[104:107], v15 offset:5120
    v_lshlrev_b32 v186, 16, v151
    v_mfma_f32_16x16x32_bf16 v[40:43], a[108:111], a[172:175], 0
    ds_read_b128 a[200:203], v11 offset:39040
    v_fma_f32 v73, v97, s17, v73
    v_mfma_f32_16x16x32_bf16 v[40:43], v[208:211], a[176:179], v[40:43]
    ds_read_b128 a[204:207], v11 offset:39232
    v_and_b32 v187, s16, v151
    v_mfma_f32_16x16x32_bf16 v[40:43], a[120:123], a[180:183], v[40:43]
    v_fma_f32 v74, v98, s17, v74
    v_fma_f32 v75, v99, s17, v75
    v_mfma_f32_16x16x32_bf16 v[44:47], v[204:207], a[172:175], 0
    ds_read_b128 v[96:99], v15 offset:6144
    v_sub_f32 v196, v180, v196
    v_mfma_f32_16x16x32_bf16 v[44:47], a[116:119], a[176:179], v[44:47]
    v_cvt_pk_bf16_f32 v72, v72, v73
    v_sub_f32 v197, v181, v197
    v_mfma_f32_16x16x32_bf16 v[44:47], v[216:219], a[180:183], v[44:47]
    v_cvt_pk_bf16_f32 v73, v74, v75
    v_cvt_pk_bf16_f32 v116, v196, v197
    v_mfma_f32_16x16x32_bf16 v[48:51], v[200:203], a[176:179], 0
    s_waitcnt lgkmcnt(6)
    v_fma_f32 v76, v100, s17, v76
    v_fma_f32 v77, v101, s17, v77
    v_mfma_f32_16x16x32_bf16 v[48:51], a[112:115], a[180:183], v[48:51]
    ds_write2_b64 v16, v[68:69], v[72:73] offset0:8 offset1:24
    v_mfma_f32_16x16x32_bf16 v[48:51], v[212:215], a[184:187], v[48:51]
    v_sub_f32 v198, v182, v198
    v_fma_f32 v78, v102, s17, v78
    v_mfma_f32_16x16x32_bf16 v[52:55], a[108:111], a[176:179], 0
    v_sub_f32 v199, v183, v199
    v_fma_f32 v79, v103, s17, v79
    v_mfma_f32_16x16x32_bf16 v[52:55], v[208:211], a[180:183], v[52:55]
    ds_read_b128 v[100:103], v15 offset:7168
    v_cvt_pk_bf16_f32 v76, v76, v77
    v_mfma_f32_16x16x32_bf16 v[52:55], a[120:123], a[184:187], v[52:55]
    v_cvt_pk_bf16_f32 v117, v198, v199
    v_cvt_pk_bf16_f32 v77, v78, v79
    v_mfma_f32_16x16x32_bf16 v[56:59], v[204:207], a[176:179], 0
    s_waitcnt lgkmcnt(5)
    v_sub_f32 v124, v184, v124
    v_fma_f32 v80, v104, s17, v80
    v_mfma_f32_16x16x32_bf16 v[56:59], a[116:119], a[180:183], v[56:59]
    v_sub_f32 v125, v185, v125
    v_fma_f32 v81, v105, s17, v81
    v_mfma_f32_16x16x32_bf16 v[56:59], v[216:219], a[184:187], v[56:59]
    s_waitcnt lgkmcnt(3)
    v_fma_f32 v82, v106, s17, v82
    v_cvt_pk_bf16_f32 v118, v124, v125
    v_mfma_f32_16x16x32_bf16 v[24:27], a[124:127], a[188:191], v[24:27]
    v_fma_f32 v83, v107, s17, v83
    v_sub_f32 v126, v186, v126
    v_mfma_f32_16x16x32_bf16 v[24:27], v[224:227], a[192:195], v[24:27]
    ds_read_b128 v[104:107], v15 offset:8192
    v_cvt_pk_bf16_f32 v80, v80, v81
    v_mfma_f32_16x16x32_bf16 v[24:27], a[136:139], a[196:199], v[24:27]
    ds_read_b128 a[168:171], v10 offset:38528
    v_cvt_pk_bf16_f32 v81, v82, v83
    v_mfma_f32_16x16x32_bf16 v[28:31], v[220:223], a[188:191], v[28:31]
    s_waitcnt lgkmcnt(4)
    v_sub_f32 v127, v187, v127
    v_fma_f32 v84, v96, s17, v84
    v_mfma_f32_16x16x32_bf16 v[28:31], a[132:135], a[192:195], v[28:31]
    ds_write2_b64 v16, v[76:77], v[80:81] offset0:28 offset1:32
    v_mfma_f32_16x16x32_bf16 v[28:31], v[232:235], a[196:199], v[28:31]
    v_cvt_pk_bf16_f32 v119, v126, v127
    v_fma_f32 v85, v97, s17, v85
    v_mfma_f32_16x16x32_bf16 v[32:35], a[128:131], a[188:191], v[32:35]
    s_waitcnt vmcnt(5)
    v_fma_f32 v86, v98, s17, v86
    v_fma_f32 v87, v99, s17, v87
    v_mfma_f32_16x16x32_bf16 v[32:35], v[228:231], a[192:195], v[32:35]
    ds_write_b128 v8, v[116:119] offset:28800
    v_mfma_f32_16x16x32_bf16 v[32:35], a[140:143], a[196:199], v[32:35]
    v_lshlrev_b32 v164, 16, v142
    v_cvt_pk_bf16_f32 v84, v84, v85
    v_mfma_f32_16x16x32_bf16 v[36:39], a[124:127], a[192:195], v[36:39]
    v_and_b32 v165, s16, v142
    v_cvt_pk_bf16_f32 v85, v86, v87
    v_mfma_f32_16x16x32_bf16 v[36:39], v[224:227], a[196:199], v[36:39]
    s_waitcnt lgkmcnt(4)
    v_lshlrev_b32 v166, 16, v143
    v_fma_f32 v88, v100, s17, v88
    v_mfma_f32_16x16x32_bf16 v[36:39], a[136:139], a[200:203], v[36:39]
    ds_read_b128 a[172:175], v10 offset:38720
    v_fma_f32 v89, v101, s17, v89
    v_mfma_f32_16x16x32_bf16 v[40:43], v[220:223], a[192:195], v[40:43]
    ds_read_b128 a[176:179], v10 offset:38912
    v_and_b32 v167, s16, v143
    v_mfma_f32_16x16x32_bf16 v[40:43], a[132:135], a[196:199], v[40:43]
    ds_read_b128 a[180:183], v11 offset:39104
    v_fma_f32 v90, v102, s17, v90
    v_mfma_f32_16x16x32_bf16 v[40:43], v[232:235], a[200:203], v[40:43]
    ds_read_b128 a[184:187], v11 offset:39296
    v_sub_f32 v172, v164, v172
    v_mfma_f32_16x16x32_bf16 v[44:47], a[128:131], a[192:195], v[44:47]
    v_fma_f32 v91, v103, s17, v91
    v_cvt_pk_bf16_f32 v88, v88, v89
    v_mfma_f32_16x16x32_bf16 v[44:47], v[228:231], a[196:199], v[44:47]
    v_sub_f32 v173, v165, v173
    v_cvt_pk_bf16_f32 v89, v90, v91
    v_mfma_f32_16x16x32_bf16 v[44:47], a[140:143], a[200:203], v[44:47]
    s_waitcnt lgkmcnt(7)
    v_cvt_pk_bf16_f32 v120, v172, v173
    v_fma_f32 v92, v104, s17, v92
    v_mfma_f32_16x16x32_bf16 v[48:51], a[124:127], a[196:199], v[48:51]
    ds_write2_b64 v16, v[84:85], v[88:89] offset0:48 offset1:52
    v_mfma_f32_16x16x32_bf16 v[48:51], v[224:227], a[200:203], v[48:51]
    v_sub_f32 v174, v166, v174
    v_fma_f32 v93, v105, s17, v93
    v_mfma_f32_16x16x32_bf16 v[48:51], a[136:139], a[204:207], v[48:51]
    v_fma_f32 v94, v106, s17, v94
    v_sub_f32 v175, v167, v175
    v_mfma_f32_16x16x32_bf16 v[52:55], v[220:223], a[196:199], v[52:55]
    v_fma_f32 v95, v107, s17, v95
    v_cvt_pk_bf16_f32 v121, v174, v175
    v_mfma_f32_16x16x32_bf16 v[52:55], a[132:135], a[200:203], v[52:55]
    ds_write_b64 v9, v[120:121] offset:28800
    v_mfma_f32_16x16x32_bf16 v[52:55], v[232:235], a[204:207], v[52:55]
    s_mul_i32 s0, s32, 9472
    v_cvt_pk_bf16_f32 v92, v92, v93
    v_cvt_pk_bf16_f32 v93, v94, v95
    v_mfma_f32_16x16x32_bf16 v[56:59], a[128:131], a[196:199], v[56:59]
    s_mul_i32 s1, s33, 4736
    v_mfma_f32_16x16x32_bf16 v[56:59], v[228:231], a[200:203], v[56:59]
    ds_write_b64 v16, v[92:93] offset:448
    v_mfma_f32_16x16x32_bf16 v[56:59], a[140:143], a[204:207], v[56:59]
    s_waitcnt lgkmcnt(3)
    v_mfma_f32_16x16x32_bf16 v[24:27], v[236:239], a[168:171], v[24:27]
    s_add_u32 s0, s0, s1
    v_mfma_f32_16x16x32_bf16 v[24:27], a[148:151], a[172:175], v[24:27]
    s_add_u32 s0, s0, 113664
    v_mfma_f32_16x16x32_bf16 v[24:27], a[156:159], a[176:179], v[24:27]
    s_mul_i32 s1, s33, 4608
    v_mfma_f32_16x16x32_bf16 v[28:31], a[144:147], a[168:171], v[28:31]
    s_waitcnt lgkmcnt(0)
    s_barrier
    v_mfma_f32_16x16x32_bf16 v[28:31], v[244:247], a[172:175], v[28:31]
    ds_read_b128 a[208:211], v17
    v_mfma_f32_16x16x32_bf16 v[28:31], a[160:163], a[176:179], v[28:31]
L_stub5:
    s_cbranch_execz L_back
    s_nop 0
    ds_write_b128 v14, v[24:27] offset:0
    v_mfma_f32_16x16x32_bf16 v[32:35], v[240:243], a[168:171], v[32:35]
    s_add_u32 s1, s1, s42
    v_lshrrev_b32 v152, 4, v0
    v_and_b32 v153, 15, v0
    v_mfma_f32_16x16x32_bf16 v[32:35], a[152:155], a[172:175], v[32:35]
    v_mad_u32_u24 v154, v152, 37, v153
    v_mad_u32_u24 v154, v152, 37, v154
    v_mfma_f32_16x16x32_bf16 v[32:35], a[164:167], a[176:179], v[32:35]
    ds_read_b128 a[212:215], v18
    v_lshl_add_u32 v160, v154, 4, s0
    v_mfma_f32_16x16x32_bf16 v[36:39], v[236:239], a[172:175], v[36:39]
    ds_write_b128 v14, v[28:31] offset:1024
    v_mfma_f32_16x16x32_bf16 v[36:39], a[148:151], a[176:179], v[36:39]
    v_lshlrev_b32 v152, 1, v152
    v_sub_u32 v154, v154, v152
    v_mfma_f32_16x16x32_bf16 v[36:39], a[156:159], a[180:183], v[36:39]
    v_lshl_add_u32 v162, v154, 4, s1
    v_cmp_gt_u32 vcc, 8, v153
    v_mfma_f32_16x16x32_bf16 v[40:43], a[144:147], a[172:175], v[40:43]
    ds_read_b128 a[188:191], v12 offset:38400
    v_bfrev_b32 v155, 1
    v_mfma_f32_16x16x32_bf16 v[40:43], v[244:247], a[176:179], v[40:43]
    ds_read_b128 a[216:219], v19
    v_add_u32 v154, 256, v162
    v_mfma_f32_16x16x32_bf16 v[40:43], a[160:163], a[180:183], v[40:43]
    ds_read_b128 a[192:195], v12 offset:38592
    v_cndmask_b32 v163, v155, v154, vcc
    v_mfma_f32_16x16x32_bf16 v[44:47], v[240:243], a[172:175], v[44:47]
    ds_write_b128 v14, v[32:35] offset:2048
    v_mfma_f32_16x16x32_bf16 v[44:47], a[152:155], a[176:179], v[44:47]
    s_waitcnt lgkmcnt(7)
    v_and_b32 v154, 8, v0
    v_lshlrev_b32 v154, 4, v154
    v_mfma_f32_16x16x32_bf16 v[44:47], a[164:167], a[180:183], v[44:47]
    buffer_store_dwordx4 a[208:211], v22, s[24:27], s38 offen offset:0 sc0 sc1
    v_mfma_f32_16x16x32_bf16 v[48:51], v[236:239], a[176:179], v[48:51]
    ds_read_b128 a[196:199], v12 offset:38784
    v_sub_u32 v165, v160, v154
    v_mfma_f32_16x16x32_bf16 v[48:51], a[148:151], a[180:183], v[48:51]
    ds_read_b128 a[200:203], v13 offset:38976
    v_and_b32 v153, 31, v0
    v_mfma_f32_16x16x32_bf16 v[48:51], a[156:159], a[184:187], v[48:51]
    ds_read_b128 a[220:223], v20
    v_and_b32 v154, 16, v0
    v_mfma_f32_16x16x32_bf16 v[52:55], a[144:147], a[176:179], v[52:55]
    ds_write_b128 v14, v[36:39] offset:3072
    v_mfma_f32_16x16x32_bf16 v[52:55], v[244:247], a[180:183], v[52:55]
    s_waitcnt lgkmcnt(9)
    v_add3_u32 v153, v153, v154, 24
    v_lshrrev_b32 v152, 5, v0
    v_mfma_f32_16x16x32_bf16 v[52:55], a[160:163], a[184:187], v[52:55]
    buffer_store_dwordx4 a[212:215], v22, s[24:27], s38 offen offset:1024 sc0 sc1
    v_mfma_f32_16x16x32_bf16 v[56:59], v[240:243], a[176:179], v[56:59]
    ds_write_b128 v14, v[40:43] offset:4096
    v_mfma_f32_16x16x32_bf16 v[56:59], a[152:155], a[180:183], v[56:59]
    ds_read_b128 a[224:227], v21
    v_mfma_f32_16x16x32_bf16 v[56:59], a[164:167], a[184:187], v[56:59]
    s_waitcnt lgkmcnt(4)
    v_mad_u32_u24 v154, v152, 36, v153
    v_mad_u32_u24 v154, v152, 36, v154
    v_mfma_f32_16x16x32_bf16 v[60:63], a[0:3], a[188:191], v[24:27]
    ds_write_b128 v14, v[44:47] offset:5120
    v_mfma_f32_16x16x32_bf16 v[60:63], a[12:15], a[192:195], v[60:63]
    v_lshl_add_u32 v164, v154, 4, s1
    v_cmp_le_u32 vcc, 36, v153
    v_mfma_f32_16x16x32_bf16 v[60:63], a[24:27], a[196:199], v[60:63]
    buffer_store_dwordx4 a[216:219], v22, s[24:27], s38 offen offset:2048 sc0 sc1
    v_mfma_f32_16x16x32_bf16 v[64:67], a[4:7], a[188:191], v[28:31]
    ds_write_b128 v14, v[48:51] offset:6144
    v_mfma_f32_16x16x32_bf16 v[64:67], a[16:19], a[192:195], v[64:67]
    s_waitcnt lgkmcnt(5)
    v_lshl_add_u32 v154, v152, 1, v154
    v_lshl_add_u32 v161, v154, 4, s0
    v_mfma_f32_16x16x32_bf16 v[64:67], a[28:31], a[196:199], v[64:67]
    v_add_u32 v154, 16, v161
    v_cndmask_b32 v161, v161, v154, vcc
    v_mfma_f32_16x16x32_bf16 v[68:71], a[8:11], a[188:191], v[32:35]
    ds_read_b128 a[168:171], v12 offset:38464
    v_mfma_f32_16x16x32_bf16 v[68:71], a[20:23], a[192:195], v[68:71]
    ds_read_b128 a[172:175], v12 offset:38656
    v_mfma_f32_16x16x32_bf16 v[68:71], a[32:35], a[196:199], v[68:71]
    ds_read_b128 a[176:179], v12 offset:38848
    v_mfma_f32_16x16x32_bf16 v[72:75], a[0:3], a[192:195], v[36:39]
    ds_write_b128 v14, v[52:55] offset:7168
    v_mfma_f32_16x16x32_bf16 v[72:75], a[12:15], a[196:199], v[72:75]
    ds_read_b128 a[180:183], v13 offset:39040
    v_mfma_f32_16x16x32_bf16 v[72:75], a[24:27], a[200:203], v[72:75]
    buffer_store_dwordx4 a[220:223], v22, s[24:27], s38 offen offset:3072 sc0 sc1
    v_mfma_f32_16x16x32_bf16 v[76:79], a[4:7], a[192:195], v[40:43]
    ds_write_b128 v14, v[56:59] offset:8192
    v_mfma_f32_16x16x32_bf16 v[76:79], a[16:19], a[196:199], v[76:79]
    s_waitcnt lgkmcnt(8)
    v_mfma_f32_16x16x32_bf16 v[76:79], a[28:31], a[200:203], v[76:79]
    v_mfma_f32_16x16x32_bf16 v[80:83], a[8:11], a[192:195], v[44:47]
    v_mfma_f32_16x16x32_bf16 v[80:83], a[20:23], a[196:199], v[80:83]
    buffer_store_dwordx4 a[224:227], v23, s[24:27], s38 offen sc0 sc1
    v_mfma_f32_16x16x32_bf16 v[80:83], a[32:35], a[200:203], v[80:83]
    s_waitcnt lgkmcnt(1)
    s_waitcnt lgkmcnt(0)
    s_barrier
    v_mfma_f32_16x16x32_bf16 v[60:63], a[36:39], a[168:171], v[60:63]
    ds_read_b128 v[96:99], v15 offset:0
    v_mfma_f32_16x16x32_bf16 v[60:63], a[48:51], a[172:175], v[60:63]
    ds_read_b128 v[100:103], v15 offset:1024
    v_mfma_f32_16x16x32_bf16 v[60:63], a[60:63], a[176:179], v[60:63]
    s_add_u32 s38, s38, s98
    v_mfma_f32_16x16x32_bf16 v[64:67], a[40:43], a[168:171], v[64:67]
    ds_read_b128 v[104:107], v15 offset:2048
    v_mfma_f32_16x16x32_bf16 v[64:67], a[52:55], a[172:175], v[64:67]
    ds_read_b128 a[188:191], v12 offset:38528
    v_mfma_f32_16x16x32_bf16 v[64:67], a[64:67], a[176:179], v[64:67]
    ds_read_b128 a[192:195], v12 offset:38720
    v_mfma_f32_16x16x32_bf16 v[68:71], a[44:47], a[168:171], v[68:71]
    ds_read_b128 v[168:171], v15 offset:3072
    v_mfma_f32_16x16x32_bf16 v[68:71], a[56:59], a[172:175], v[68:71]
    ds_read_b128 a[196:199], v12 offset:38912
    v_mfma_f32_16x16x32_bf16 v[68:71], a[68:71], a[176:179], v[68:71]
    ds_read_b128 a[200:203], v13 offset:39104
    v_mfma_f32_16x16x32_bf16 v[72:75], a[36:39], a[172:175], v[72:75]
    ds_read_b128 v[172:175], v15 offset:4096
    v_mfma_f32_16x16x32_bf16 v[72:75], a[48:51], a[176:179], v[72:75]
    s_waitcnt lgkmcnt(8)
    v_fma_f32 v60, v96, s17, v60
    v_fma_f32 v61, v97, s17, v61
    v_mfma_f32_16x16x32_bf16 v[72:75], a[60:63], a[180:183], v[72:75]
    ds_read_b128 v[176:179], v15 offset:5120
    v_fma_f32 v62, v98, s17, v62
    v_mfma_f32_16x16x32_bf16 v[76:79], a[40:43], a[172:175], v[76:79]
    ds_read_b128 v[180:183], v15 offset:6144
    v_fma_f32 v63, v99, s17, v63
    v_mfma_f32_16x16x32_bf16 v[76:79], a[52:55], a[176:179], v[76:79]
    s_waitcnt lgkmcnt(9)
    v_fma_f32 v64, v100, s17, v64
    v_fma_f32 v65, v101, s17, v65
    v_mfma_f32_16x16x32_bf16 v[76:79], a[64:67], a[180:183], v[76:79]
    ds_read_b128 v[184:187], v15 offset:7168
    v_fma_f32 v66, v102, s17, v66
    v_mfma_f32_16x16x32_bf16 v[80:83], a[44:47], a[172:175], v[80:83]
    ds_read_b128 v[188:191], v15 offset:8192
    v_fma_f32 v67, v103, s17, v67
    v_mfma_f32_16x16x32_bf16 v[80:83], a[56:59], a[176:179], v[80:83]
    s_waitcnt lgkmcnt(10)
    v_fma_f32 v68, v104, s17, v68
    v_fma_f32 v69, v105, s17, v69
    v_mfma_f32_16x16x32_bf16 v[80:83], a[68:71], a[180:183], v[80:83]
    s_waitcnt lgkmcnt(5)
    v_fma_f32 v70, v106, s17, v70
    v_fma_f32 v71, v107, s17, v71
    v_mfma_f32_16x16x32_bf16 v[60:63], a[72:75], a[188:191], v[60:63]
    v_fma_f32 v72, v168, s17, v72
    v_fma_f32 v73, v169, s17, v73
    v_mfma_f32_16x16x32_bf16 v[60:63], a[84:87], a[192:195], v[60:63]
    ds_read_b128 a[168:171], v12 offset:38784
    v_fma_f32 v74, v170, s17, v74
    v_mfma_f32_16x16x32_bf16 v[60:63], a[96:99], a[196:199], v[60:63]
    ds_read_b128 a[172:175], v13 offset:38976
    v_fma_f32 v75, v171, s17, v75
    v_mfma_f32_16x16x32_bf16 v[64:67], a[76:79], a[188:191], v[64:67]
    s_waitcnt lgkmcnt(6)
    v_fma_f32 v76, v172, s17, v76
    v_fma_f32 v77, v173, s17, v77
    v_mfma_f32_16x16x32_bf16 v[64:67], a[88:91], a[192:195], v[64:67]
    ds_read_b128 a[176:179], v13 offset:39168
    v_fma_f32 v78, v174, s17, v78
    v_mfma_f32_16x16x32_bf16 v[64:67], a[100:103], a[196:199], v[64:67]
    ds_read_b128 a[180:183], v12 offset:38848
    v_cvt_pk_bf16_f32 v60, v60, v61
    v_mfma_f32_16x16x32_bf16 v[68:71], a[80:83], a[188:191], v[68:71]
    ds_read_b128 a[184:187], v13 offset:39040
    v_cvt_pk_bf16_f32 v61, v62, v63
    v_mfma_f32_16x16x32_bf16 v[68:71], a[92:95], a[192:195], v[68:71]
    ds_read_b128 a[228:231], v13 offset:39232
    v_fma_f32 v79, v175, s17, v79
    v_mfma_f32_16x16x32_bf16 v[68:71], a[104:107], a[196:199], v[68:71]
    s_waitcnt lgkmcnt(9)
    v_cvt_pk_bf16_f32 v64, v64, v65
    v_cvt_pk_bf16_f32 v65, v66, v67
    v_mfma_f32_16x16x32_bf16 v[72:75], a[72:75], a[192:195], v[72:75]
    ds_write2_b64 v16, v[60:61], v[64:65] offset0:0 offset1:4
    v_mfma_f32_16x16x32_bf16 v[72:75], a[84:87], a[196:199], v[72:75]
    v_fma_f32 v80, v176, s17, v80
    v_fma_f32 v81, v177, s17, v81
    v_mfma_f32_16x16x32_bf16 v[72:75], a[96:99], a[200:203], v[72:75]
    v_cvt_pk_bf16_f32 v68, v68, v69
    v_fma_f32 v82, v178, s17, v82
    v_mfma_f32_16x16x32_bf16 v[76:79], a[76:79], a[192:195], v[76:79]
    v_cvt_pk_bf16_f32 v69, v70, v71
    v_fma_f32 v83, v179, s17, v83
    v_mfma_f32_16x16x32_bf16 v[76:79], a[88:91], a[196:199], v[76:79]
    s_waitcnt lgkmcnt(9)
    v_fma_f32 v48, v180, s17, v48
    v_fma_f32 v49, v181, s17, v49
    v_mfma_f32_16x16x32_bf16 v[76:79], a[100:103], a[200:203], v[76:79]
    v_cvt_pk_bf16_f32 v72, v72, v73
    v_fma_f32 v50, v182, s17, v50
    v_mfma_f32_16x16x32_bf16 v[80:83], a[80:83], a[192:195], v[80:83]
    v_cvt_pk_bf16_f32 v73, v74, v75
    v_fma_f32 v51, v183, s17, v51
    v_mfma_f32_16x16x32_bf16 v[80:83], a[92:95], a[196:199], v[80:83]
    s_waitcnt lgkmcnt(8)
    v_fma_f32 v52, v184, s17, v52
    v_fma_f32 v53, v185, s17, v53
    v_mfma_f32_16x16x32_bf16 v[80:83], a[104:107], a[200:203], v[80:83]
    s_waitcnt lgkmcnt(4)
    v_cvt_pk_bf16_f32 v76, v76, v77
    v_fma_f32 v54, v186, s17, v54
    v_mfma_f32_16x16x32_bf16 v[84:87], a[0:3], a[168:171], v[48:51]
    ds_write2_b64 v16, v[68:69], v[72:73] offset0:8 offset1:24
    v_cvt_pk_bf16_f32 v77, v78, v79
    v_mfma_f32_16x16x32_bf16 v[84:87], a[12:15], a[172:175], v[84:87]
    v_fma_f32 v55, v187, s17, v55
    v_mfma_f32_16x16x32_bf16 v[84:87], a[24:27], a[176:179], v[84:87]
    v_fma_f32 v56, v188, s17, v56
    v_fma_f32 v57, v189, s17, v57
    v_cvt_pk_bf16_f32 v80, v80, v81
    v_mfma_f32_16x16x32_bf16 v[88:91], a[4:7], a[168:171], v[52:55]
    ds_read_b128 a[188:191], v12 offset:38912
    v_fma_f32 v58, v190, s17, v58
    v_cvt_pk_bf16_f32 v81, v82, v83
    v_mfma_f32_16x16x32_bf16 v[88:91], a[16:19], a[172:175], v[88:91]
    ds_write2_b64 v16, v[76:77], v[80:81] offset0:28 offset1:32
    v_fma_f32 v59, v191, s17, v59
    v_mfma_f32_16x16x32_bf16 v[88:91], a[28:31], a[176:179], v[88:91]
    s_nop 0
    v_mfma_f32_16x16x32_bf16 v[92:95], a[8:11], a[168:171], v[56:59]
    s_waitcnt lgkmcnt(0)
    s_barrier
    v_mfma_f32_16x16x32_bf16 v[92:95], a[20:23], a[172:175], v[92:95]
    ds_read_b128 a[208:211], v160
    v_mfma_f32_16x16x32_bf16 v[92:95], a[32:35], a[176:179], v[92:95]
    ds_read_b128 a[192:195], v13 offset:39104
    v_mfma_f32_16x16x32_bf16 v[84:87], a[36:39], a[180:183], v[84:87]
    ds_read_b128 a[212:215], v160 offset:656
    v_mfma_f32_16x16x32_bf16 v[84:87], a[48:51], a[184:187], v[84:87]
    ds_read_b128 a[196:199], v13 offset:39296
    v_mfma_f32_16x16x32_bf16 v[84:87], a[60:63], a[228:231], v[84:87]
    ds_read_b128 a[216:219], v165 offset:256
    v_mfma_f32_16x16x32_bf16 v[88:91], a[40:43], a[180:183], v[88:91]
    v_mfma_f32_16x16x32_bf16 v[88:91], a[52:55], a[184:187], v[88:91]
    s_waitcnt lgkmcnt(4)
    v_mfma_f32_16x16x32_bf16 v[88:91], a[64:67], a[228:231], v[88:91]
    buffer_store_dwordx4 a[208:211], v162, s[24:27], s38 offen offset:0 sc0 sc1
    v_mfma_f32_16x16x32_bf16 v[92:95], a[44:47], a[180:183], v[92:95]
    s_waitcnt lgkmcnt(2)
    v_mfma_f32_16x16x32_bf16 v[92:95], a[56:59], a[184:187], v[92:95]
    buffer_store_dwordx4 a[212:215], v162, s[24:27], s38 offen offset:640 sc0 sc1
    v_mfma_f32_16x16x32_bf16 v[92:95], a[68:71], a[228:231], v[92:95]
    s_waitcnt lgkmcnt(1)
    s_waitcnt lgkmcnt(0)
    v_mfma_f32_16x16x32_bf16 v[84:87], a[72:75], a[188:191], v[84:87]
    buffer_store_dwordx4 a[216:219], v163, s[24:27], s38 offen offset:0 sc0 sc1
    v_mfma_f32_16x16x32_bf16 v[84:87], a[84:87], a[192:195], v[84:87]
    v_mfma_f32_16x16x32_bf16 v[84:87], a[96:99], a[196:199], v[84:87]
    v_mfma_f32_16x16x32_bf16 v[88:91], a[76:79], a[188:191], v[88:91]
    s_nop 1
    v_mfma_f32_16x16x32_bf16 v[88:91], a[88:91], a[192:195], v[88:91]
    s_nop 2
    v_mfma_f32_16x16x32_bf16 v[88:91], a[100:103], a[196:199], v[88:91]
    v_cvt_pk_bf16_f32 v84, v84, v85
    v_cvt_pk_bf16_f32 v85, v86, v87
    v_mfma_f32_16x16x32_bf16 v[92:95], a[80:83], a[188:191], v[92:95]
    v_mfma_f32_16x16x32_bf16 v[92:95], a[92:95], a[192:195], v[92:95]
    s_nop 2
    v_mfma_f32_16x16x32_bf16 v[92:95], a[104:107], a[196:199], v[92:95]
    v_cvt_pk_bf16_f32 v88, v88, v89
    v_cvt_pk_bf16_f32 v89, v90, v91
    ds_write2_b64 v16, v[84:85], v[88:89] offset0:48 offset1:52
    s_nop 2
    s_nop 1
    v_cvt_pk_bf16_f32 v92, v92, v93
    v_cvt_pk_bf16_f32 v93, v94, v95
    ds_write_b64 v16, v[92:93] offset:448
    s_waitcnt lgkmcnt(0)
    s_barrier
    ds_read_b128 a[220:223], v161
    ds_read_b128 a[224:227], v161 offset:2368
    s_waitcnt lgkmcnt(1)
    buffer_store_dwordx4 a[220:223], v164, s[24:27], s38 offen offset:0 sc0 sc1
    s_waitcnt lgkmcnt(0)
    buffer_store_dwordx4 a[224:227], v164, s[24:27], s38 offen offset:2304 sc0 sc1
L_end:
    s_endpgm
.section .rodata,"a"
.p2align 6
.amdhsa_kernel standalone__winograd__vision_kernel
  .amdhsa_next_free_vgpr 512
  .amdhsa_next_free_sgpr 102
  .amdhsa_accum_offset 256
  .amdhsa_group_segment_fixed_size 0
  .amdhsa_kernarg_size 40
  .amdhsa_user_sgpr_count 2
  .amdhsa_user_sgpr_kernarg_segment_ptr 1
  .amdhsa_system_sgpr_workgroup_id_x 1
  .amdhsa_float_denorm_mode_32 3
.end_amdhsa_kernel
```
